```python
import torch

def _softmax(x, axis=-1):
    return torch.softmax(x, dim=axis)

def _gelu(x):
    return torch.nn.functional.gelu(x, approximate='tanh')

def _silu(x):
    return torch.nn.functional.silu(x)

def _sigmoid(x):
    return torch.sigmoid(x)

def _layernorm(x, axis=-1, eps=1e-05):
    m = x.mean(dim=axis, keepdim=True)
    v = x.var(dim=axis, keepdim=True, unbiased=False)
    return (x - m) / torch.sqrt(v + eps)

def _scatter_add(tgt, idx, src, axis=0):
    return tgt.clone().index_add_(axis, idx, src)

def _segment_sum(src, seg, n):
    out = torch.zeros((n,) + src.shape[1:], dtype=src.dtype)
    return out.index_add_(0, seg, src)

def _pad(x, pw):
    flat = tuple((v for pair in reversed(pw) for v in pair))
    return torch.nn.functional.pad(x, flat)
kernel_name = 'adaLN_cond__sliding_local_dilated__glu_gated_reglu__prompt'

def setup_inputs():

    _w = lambda a: (lambda t: t.to(torch.bfloat16) if t.is_floating_point() else t)(torch.as_tensor(a))

    def _A_setup():
        B, S, D = (1, 2048, 512)
        return {'x': _w((lambda *s: torch.randn(*s, dtype=torch.bfloat16) * 0.05)(B, S, D)), 'wqkv': _w((lambda *s: torch.randn(*s, dtype=torch.bfloat16) * 0.05)(D, 3 * D)), 'wo': _w((lambda *s: torch.randn(*s, dtype=torch.bfloat16) * 0.05)(D, D))}
    _A_in = _A_setup()

    def _B_setup():
        B, S, D, F = (1, 2048, 512, 1792)
        return {'x': _w((lambda *s: torch.randn(*s, dtype=torch.bfloat16) * 0.05)(B, S, D)), 'W_gate': _w((lambda *s: torch.randn(*s, dtype=torch.bfloat16) * 0.8)(D, F) * (2.0 / D) ** 0.5), 'W_up': _w((lambda *s: torch.randn(*s, dtype=torch.bfloat16) * 0.8)(D, F) * (2.0 / D) ** 0.5), 'W_down': _w((lambda *s: torch.randn(*s, dtype=torch.bfloat16) * 0.8)(F, D) * (1.0 / F) ** 0.5)}
    _B_in = _B_setup()
    return {'A_x': _A_in['x'], 'A_wqkv': _A_in['wqkv'], 'A_wo': _A_in['wo'], 'B_x': _B_in['x'], 'B_W_gate': _B_in['W_gate'], 'B_W_up': _B_in['W_up'], 'B_W_down': _B_in['W_down'], 'c': _w((lambda *s: torch.randn(*s, dtype=torch.bfloat16) * 0.1)(1, 512) * 8.0), 'w_mod': _w((lambda *s: torch.randn(*s, dtype=torch.bfloat16) * 0.1)(512, 6 * 512) * 512 ** (-0.5) * 8.0)}

def reference(A_x, A_wqkv, A_wo, B_x, B_W_gate, B_W_up, B_W_down, c, w_mod):

    def _A_ref(x, wqkv, wo):
        B, S, D = x.shape
        H = 32
        Dh = D // H
        W, dil = (8, 2)
        qkv = (lambda x, *d: x.permute(*d))((x @ wqkv).reshape(B, S, 3, H, Dh), 2, 0, 3, 1, 4)
        q, k, v = (qkv[0], qkv[1], qkv[2])
        scale = Dh ** (-0.5)
        pos = torch.arange(S)
        off = torch.arange(W) * dil
        idx = pos[:, None] - off[None, :]
        mask = idx >= 0
        idx_c = torch.where(mask, idx, 0).reshape(-1)
        kg = k[:, :, idx_c, :].reshape(B, H, S, W, Dh)
        vg = v[:, :, idx_c, :].reshape(B, H, S, W, Dh)
        logits = torch.einsum('bhsd,bhswd->bhsw', q, kg) * scale
        logits = torch.where(mask[None, None, :, :], logits, -1000000000.0)
        attn = _softmax(logits, axis=-1)
        o = torch.einsum('bhsw,bhswd->bhsd', attn, vg)
        return (lambda x, *d: x.permute(*d))(o, 0, 2, 1, 3).reshape(B, S, D) @ wo

    def _B_ref(x, W_gate, W_up, W_down):
        gate = torch.einsum('bsd,df->bsf', x, W_gate)
        up = torch.einsum('bsd,df->bsf', x, W_up)
        gate = gate * (lambda x, dt: x.to(dt))(gate > 0, gate.dtype)
        h = gate * up
        return torch.einsum('bsf,fd->bsd', h, W_down)
    x = A_x
    mod = (_silu(c) @ w_mod).reshape(c.shape[0], 6, 1, -1)
    sa, ca, ga, sb, cb, gb = (mod[:, 0].clone(), mod[:, 1].clone(), mod[:, 2].clone(), mod[:, 3].clone(), mod[:, 4].clone(), mod[:, 5].clone())
    h = _layernorm(x, axis=-1) * (1 + ca) + sa
    x = x + ga * _A_ref(h, A_wqkv, A_wo)
    h = _layernorm(x, axis=-1) * (1 + cb) + sb
    x = x + gb * _B_ref(h, B_W_gate, B_W_up, B_W_down)
    return x
```

```asm
; @launch grid=(256,1,1) block=(512,1,1) lds=163840
.amdgcn_target "amdgcn-amd-amdhsa--gfx950"
.text
.globl adaLN_cond__sliding_local_dilated__glu_gated_reglu__prompt_kernel
.p2align 8
.type adaLN_cond__sliding_local_dilated__glu_gated_reglu__prompt_kernel,@function
adaLN_cond__sliding_local_dilated__glu_gated_reglu__prompt_kernel:
    s_cmp_ge_u32 s2, 256
    s_cbranch_scc1 L_end
    s_load_dwordx16 s[4:19], s[0:1], 0
    s_load_dwordx2 s[40:41], s[0:1], 64
    s_load_dwordx4 s[20:23], s[0:1], 72
    s_load_dwordx2 s[28:29], s[0:1], 88
    s_memrealtime s[60:61]
    v_lshrrev_b32 v2, 6, v0
    v_and_b32 v1, 63, v0
    v_readfirstlane_b32 s26, v2
    s_and_b32 s100, s2, 7
    s_lshr_b32 s101, s2, 3
    v_lshlrev_b32 v14, 7, v1
    s_getpc_b64 s[98:99]
    s_mul_i32 s97, s101, 1536
    v_add_u32 v3, s97, v14
    v_min_u32 v3, L_end-adaLN_cond__sliding_local_dilated__glu_gated_reglu__prompt_kernel-128, v3
    s_cmp_lg_u32 s26, 6
    s_cbranch_scc1 L_ncp
    s_mov_b64 exec, 0xfff
    global_load_dword v15, v3, s[98:99]
    s_mov_b64 exec, -1
L_ncp:
    s_lshl_b32 s97, s100, 17
    s_add_u32 s96, s97, 16384
    v_lshlrev_b32 v2, 4, v1
    v_lshrrev_b32 v4, 3, v1
    v_and_b32 v5, 7, v1
    s_and_b32 s27, s26, 3
    s_lshl_b32 s49, s101, 3
    s_add_u32 s49, s49, s26
    s_lshl_b32 s51, s100, 8
    s_add_u32 s51, s51, s49
    s_lshl_b32 s51, s51, 10
    s_mov_b32 s30, 33554432
    s_mov_b32 s31, 0x20000
    s_mov_b32 s42, 3145728
    s_mov_b32 s43, 0x20000
    s_mov_b32 s38, 2097152
    s_mov_b32 s39, 0x20000
    v_mul_u32_u24 v12, 49152, v4
    v_lshl_add_u32 v12, v5, 4, v12
    s_lshl_b32 s47, s100, 7
    v_lshl_add_u32 v7, v4, 4, s47
    v_mov_b32 v29, 0
    s_and_b32 s3, s101, 15
    s_lshr_b32 s49, s101, 4
    s_add_u32 s49, s49, 1
    s_cmp_lt_u32 s26, 1
    s_cselect_b32 s49, s49, 0
    s_cmp_lg_u32 s26, 0
    s_cbranch_scc1 Lo_1
    s_setprio 2
Lo_1:
    s_cmp_lg_u32 s49, 1
    s_waitcnt lgkmcnt(0)
    s_mov_b32 s36, s4
    s_mov_b32 s37, s5
    s_cbranch_scc1 L_nw0
    global_load_dwordx4 v[240:243], v7, s[18:19]
    s_mul_i32 s53, s100, 393216
    s_lshl_b32 s52, s3, 7
    s_add_u32 s52, s52, s53
    buffer_load_dwordx4 v[176:179], v12, s[40:43], s52 offen
    s_add_u32 s52, s52, 6144
    buffer_load_dwordx4 v[180:183], v12, s[40:43], s52 offen
    s_add_u32 s52, s52, 6144
    buffer_load_dwordx4 v[184:187], v12, s[40:43], s52 offen
    s_add_u32 s52, s52, 6144
    buffer_load_dwordx4 v[188:191], v12, s[40:43], s52 offen
    s_add_u32 s52, s52, 6144
    buffer_load_dwordx4 v[192:195], v12, s[40:43], s52 offen
    s_add_u32 s52, s52, 6144
    buffer_load_dwordx4 v[196:199], v12, s[40:43], s52 offen
    s_add_u32 s52, s52, 6144
    buffer_load_dwordx4 v[200:203], v12, s[40:43], s52 offen
    s_add_u32 s52, s52, 6144
    buffer_load_dwordx4 v[204:207], v12, s[40:43], s52 offen
L_nw0:
    buffer_load_dwordx4 v[32:35], v2, s[36:39], s51 offen
    s_cmp_ge_u32 s2, 16
    s_cbranch_scc1 Lo_2
    s_sub_u32 s52, s51, 16384
    s_max_i32 s52, s52, 0
    buffer_load_dwordx4 v[36:39], v2, s[36:39], s52 offen
Lo_2:
    s_or_b32 s92, s60, 1
    s_lshr_b64 s[52:53], s[60:61], 16
    s_mov_b32 s93, s52
    s_sub_u32 s94, s60, 1200
    s_subb_u32 s95, s61, 0
    s_lshr_b64 s[52:53], s[94:95], 16
    s_mov_b32 s95, s52
    s_lshl_b32 s52, s2, 3
    s_add_u32 s52, s52, s26
    s_cmp_lg_u32 s52, 3
    s_cbranch_scc1 Lo_3
    v_mov_b32 v8, s92
    v_mov_b32 v9, s93
    s_mov_b64 exec, 1
    global_store_dwordx2 v29, v[8:9], s[22:23] sc1
    s_mov_b64 exec, -1
Lo_3:
    s_cmp_eq_u32 s100, 7
    s_cselect_b32 s25, 0, s100
    s_cmp_lg_u32 s26, 7
    s_cbranch_scc1 Lo_4
    s_lshl_b32 s53, s101, 11
    s_add_u32 s53, s53, 65536
    s_lshl_b32 s57, s101, 7
    s_add_u32 s57, s57, 14336
    v_mov_b32 v11, s53
    s_mov_b64 exec, 0x10000
    v_mov_b32 v11, s57
    s_sub_u32 s57, s57, 12416
    s_mov_b64 exec, 0x20000
    v_mov_b32 v11, s57
    s_sub_u32 s57, s57, 0xfffff080
    s_mov_b64 exec, 0x40000
    v_mov_b32 v11, s57
    s_mov_b64 exec, 0x7ffff
    v_add_u32 v11, v11, v14
    buffer_load_dword v15, v11, s[28:31], s97 offen
    s_mov_b64 exec, -1
Lo_4:
    s_lshl_b32 s44, s100, 2
    s_mul_i32 s45, s101, 37
    s_lshr_b32 s45, s45, 8
    s_mul_i32 s46, s45, 7
    s_sub_u32 s46, s101, s46
    s_cmp_eq_u32 s45, 4
    s_cselect_b32 s45, s46, s45
    s_cselect_b32 s46, 2, s46
    s_cselect_b32 s47, 2, 3
    s_add_u32 s44, s44, s45
    s_lshl_b32 s51, s44, 6
    s_add_u32 s51, s51, s26
    s_lshl_b32 s51, s51, 10
    s_sub_u32 s50, s51, 16384
    s_cmp_eq_u32 s44, 0
    s_cselect_b32 s50, s51, s50
    s_cmp_ge_u32 s46, s47
    s_addc_u32 s45, s46, 0
    s_getreg_b32 s98, hwreg(HW_REG_XCC_ID, 0, 4)
    s_lshl_b32 s98, s98, 28
    v_lshlrev_b32 v13, 2, v1
    s_mov_b32 s32, s6
    s_mov_b32 s33, s7
    s_mov_b32 s34, 1572864
    s_mov_b32 s35, 0x20000
    v_lshrrev_b32 v4, 3, v1
    v_and_b32 v3, 2, v4
    v_xor_b32 v3, v5, v3
    s_lshl_b32 s46, s26, 2
    s_and_b32 s46, s46, 4
    v_xor_b32 v3, s46, v3
    v_lshlrev_b32 v3, 4, v3
    v_lshrrev_b32 v8, 4, v1
    v_and_b32 v4, 1, v4
    v_lshl_add_u32 v4, v8, 3, v4
    v_mul_u32_u24 v8, 3072, v4
    v_add_u32 v3, v8, v3
    s_lshr_b32 s46, s26, 1
    s_lshl_b32 s46, s46, 7
    s_and_b32 s48, s100, 3
    s_lshl_b32 s47, s48, 8
    s_xor_b32 s46, s46, s47
    v_xor_b32 v16, s46, v2
    v_xor_b32 v17, 0x200, v16
    s_mov_b32 s46, s48
    s_mul_i32 s47, s27, 98304
    s_lshl_b32 s53, s45, 7
    s_add_u32 s47, s47, s53
    s_mul_i32 s48, s27, 3072
    v_mov_b32 v31, 0x3f803f80
    v_add_u32 v6, 159744, v16
    v_add_u32 v18, 159744, v17
    v_mov_b32 v30, 162816
    v_lshrrev_b32 v8, 5, v1
    v_mul_u32_u24 v27, 0x3e00, v8
    v_add_u32 v27, v27, v2
    s_cmp_ge_u32 s26, 4
    s_cbranch_scc1 Lo_5
    v_and_b32 v4, 15, v1
    v_lshrrev_b32 v5, 4, v1
    v_and_b32 v8, 7, v4
    v_lshlrev_b32 v7, 1, v8
    v_xor_b32 v7, v7, v5
    v_lshlrev_b32 v7, 4, v7
    v_lshl_add_u32 v7, v8, 8, v7
    v_lshrrev_b32 v8, 3, v4
    v_lshl_add_u32 v7, v8, 12, v7
    v_mov_b32 v22, v7
    v_xor_b32 v23, 64, v22
    v_xor_b32 v24, 128, v22
    v_xor_b32 v25, 192, v22
    v_bfe_u32 v7, v1, 2, 2
    v_lshrrev_b32 v8, 1, v7
    v_and_b32 v9, 1, v5
    v_lshl_or_b32 v8, v9, 1, v8
    v_xor_b32 v8, s27, v8
    v_mul_u32_u24 v26, 3072, v5
    v_lshl_add_u32 v26, v7, 7, v26
    v_lshl_add_u32 v26, v8, 5, v26
    v_and_b32 v9, 3, v1
    v_lshl_add_u32 v26, v9, 3, v26
    v_add_u32 v26, 81920, v26
Lo_5:
    s_cmp_lg_u32 s49, 1
    s_cbranch_scc1 L_np2
    v_and_b32 v9, 7, v1
    v_lshlrev_b32 v9, 6, v9
    v_and_b32 v10, 48, v1
    v_add_u32 v9, v9, v10
    s_lshl_b32 s53, s3, 3
    s_add_u32 s53, s53, s100
    s_lshl_b32 s53, s53, 9
    s_add_u32 s53, s53, 1572864
    s_waitcnt vmcnt(9)
    v_lshlrev_b32 v208, 16, v240
    v_and_b32 v209, 0xffff0000, v240
    v_lshlrev_b32 v210, 16, v241
    v_and_b32 v211, 0xffff0000, v241
    v_lshlrev_b32 v212, 16, v242
    v_and_b32 v213, 0xffff0000, v242
    v_lshlrev_b32 v214, 16, v243
    v_and_b32 v215, 0xffff0000, v243
    s_mov_b32 s52, 0xbfb8aa3b
    v_mul_f32 v232, s52, v208
    v_mul_f32 v233, s52, v209
    v_mul_f32 v234, s52, v210
    v_mul_f32 v235, s52, v211
    v_mul_f32 v236, s52, v212
    v_mul_f32 v237, s52, v213
    v_mul_f32 v238, s52, v214
    v_mul_f32 v239, s52, v215
    v_exp_f32 v232, v232
    v_exp_f32 v233, v233
    v_exp_f32 v234, v234
    v_exp_f32 v235, v235
    v_exp_f32 v236, v236
    v_exp_f32 v237, v237
    v_exp_f32 v238, v238
    v_exp_f32 v239, v239
    v_add_f32 v232, 1.0, v232
    v_add_f32 v233, 1.0, v233
    v_add_f32 v234, 1.0, v234
    v_add_f32 v235, 1.0, v235
    v_add_f32 v236, 1.0, v236
    v_add_f32 v237, 1.0, v237
    v_add_f32 v238, 1.0, v238
    v_add_f32 v239, 1.0, v239
    v_rcp_f32 v232, v232
    v_rcp_f32 v233, v233
    v_rcp_f32 v234, v234
    v_rcp_f32 v235, v235
    v_rcp_f32 v236, v236
    v_rcp_f32 v237, v237
    v_rcp_f32 v238, v238
    v_rcp_f32 v239, v239
    v_mul_f32 v208, v208, v232
    v_mul_f32 v209, v209, v233
    v_mul_f32 v210, v210, v234
    v_mul_f32 v211, v211, v235
    v_mul_f32 v212, v212, v236
    v_mul_f32 v213, v213, v237
    v_mul_f32 v214, v214, v238
    v_mul_f32 v215, v215, v239
    v_cvt_pk_bf16_f32 v232, v208, v209
    v_cvt_pk_bf16_f32 v234, v210, v211
    v_cvt_pk_bf16_f32 v236, v212, v213
    v_cvt_pk_bf16_f32 v238, v214, v215
    v_lshlrev_b32 v208, 16, v232
    v_and_b32 v209, 0xffff0000, v232
    v_lshlrev_b32 v210, 16, v234
    v_and_b32 v211, 0xffff0000, v234
    v_lshlrev_b32 v212, 16, v236
    v_and_b32 v213, 0xffff0000, v236
    v_lshlrev_b32 v214, 16, v238
    v_and_b32 v215, 0xffff0000, v238
    s_waitcnt vmcnt(8)
    v_lshlrev_b32 v232, 16, v176
    v_and_b32 v233, 0xffff0000, v176
    v_lshlrev_b32 v234, 16, v177
    v_and_b32 v235, 0xffff0000, v177
    v_lshlrev_b32 v236, 16, v178
    v_and_b32 v237, 0xffff0000, v178
    v_lshlrev_b32 v238, 16, v179
    v_and_b32 v239, 0xffff0000, v179
    v_pk_mul_f32 v[224:225], v[232:233], v[208:209] op_sel:[0,0] op_sel_hi:[1,0]
    v_pk_mul_f32 v[226:227], v[234:235], v[208:209] op_sel:[0,0] op_sel_hi:[1,0]
    v_pk_mul_f32 v[228:229], v[236:237], v[208:209] op_sel:[0,0] op_sel_hi:[1,0]
    v_pk_mul_f32 v[230:231], v[238:239], v[208:209] op_sel:[0,0] op_sel_hi:[1,0]
    s_waitcnt vmcnt(7)
    v_lshlrev_b32 v232, 16, v180
    v_and_b32 v233, 0xffff0000, v180
    v_lshlrev_b32 v234, 16, v181
    v_and_b32 v235, 0xffff0000, v181
    v_lshlrev_b32 v236, 16, v182
    v_and_b32 v237, 0xffff0000, v182
    v_lshlrev_b32 v238, 16, v183
    v_and_b32 v239, 0xffff0000, v183
    v_pk_fma_f32 v[224:225], v[232:233], v[208:209], v[224:225] op_sel:[0,1,0] op_sel_hi:[1,1,1]
    v_pk_fma_f32 v[226:227], v[234:235], v[208:209], v[226:227] op_sel:[0,1,0] op_sel_hi:[1,1,1]
    v_pk_fma_f32 v[228:229], v[236:237], v[208:209], v[228:229] op_sel:[0,1,0] op_sel_hi:[1,1,1]
    v_pk_fma_f32 v[230:231], v[238:239], v[208:209], v[230:231] op_sel:[0,1,0] op_sel_hi:[1,1,1]
    s_waitcnt vmcnt(6)
    v_lshlrev_b32 v232, 16, v184
    v_and_b32 v233, 0xffff0000, v184
    v_lshlrev_b32 v234, 16, v185
    v_and_b32 v235, 0xffff0000, v185
    v_lshlrev_b32 v236, 16, v186
    v_and_b32 v237, 0xffff0000, v186
    v_lshlrev_b32 v238, 16, v187
    v_and_b32 v239, 0xffff0000, v187
    v_pk_fma_f32 v[224:225], v[232:233], v[210:211], v[224:225] op_sel:[0,0,0] op_sel_hi:[1,0,1]
    v_pk_fma_f32 v[226:227], v[234:235], v[210:211], v[226:227] op_sel:[0,0,0] op_sel_hi:[1,0,1]
    v_pk_fma_f32 v[228:229], v[236:237], v[210:211], v[228:229] op_sel:[0,0,0] op_sel_hi:[1,0,1]
    v_pk_fma_f32 v[230:231], v[238:239], v[210:211], v[230:231] op_sel:[0,0,0] op_sel_hi:[1,0,1]
    s_waitcnt vmcnt(5)
    v_lshlrev_b32 v232, 16, v188
    v_and_b32 v233, 0xffff0000, v188
    v_lshlrev_b32 v234, 16, v189
    v_and_b32 v235, 0xffff0000, v189
    v_lshlrev_b32 v236, 16, v190
    v_and_b32 v237, 0xffff0000, v190
    v_lshlrev_b32 v238, 16, v191
    v_and_b32 v239, 0xffff0000, v191
    v_pk_fma_f32 v[224:225], v[232:233], v[210:211], v[224:225] op_sel:[0,1,0] op_sel_hi:[1,1,1]
    v_pk_fma_f32 v[226:227], v[234:235], v[210:211], v[226:227] op_sel:[0,1,0] op_sel_hi:[1,1,1]
    v_pk_fma_f32 v[228:229], v[236:237], v[210:211], v[228:229] op_sel:[0,1,0] op_sel_hi:[1,1,1]
    v_pk_fma_f32 v[230:231], v[238:239], v[210:211], v[230:231] op_sel:[0,1,0] op_sel_hi:[1,1,1]
    s_waitcnt vmcnt(4)
    v_lshlrev_b32 v232, 16, v192
    v_and_b32 v233, 0xffff0000, v192
    v_lshlrev_b32 v234, 16, v193
    v_and_b32 v235, 0xffff0000, v193
    v_lshlrev_b32 v236, 16, v194
    v_and_b32 v237, 0xffff0000, v194
    v_lshlrev_b32 v238, 16, v195
    v_and_b32 v239, 0xffff0000, v195
    v_pk_fma_f32 v[224:225], v[232:233], v[212:213], v[224:225] op_sel:[0,0,0] op_sel_hi:[1,0,1]
    v_pk_fma_f32 v[226:227], v[234:235], v[212:213], v[226:227] op_sel:[0,0,0] op_sel_hi:[1,0,1]
    v_pk_fma_f32 v[228:229], v[236:237], v[212:213], v[228:229] op_sel:[0,0,0] op_sel_hi:[1,0,1]
    v_pk_fma_f32 v[230:231], v[238:239], v[212:213], v[230:231] op_sel:[0,0,0] op_sel_hi:[1,0,1]
    s_waitcnt vmcnt(3)
    v_lshlrev_b32 v232, 16, v196
    v_and_b32 v233, 0xffff0000, v196
    v_lshlrev_b32 v234, 16, v197
    v_and_b32 v235, 0xffff0000, v197
    v_lshlrev_b32 v236, 16, v198
    v_and_b32 v237, 0xffff0000, v198
    v_lshlrev_b32 v238, 16, v199
    v_and_b32 v239, 0xffff0000, v199
    v_pk_fma_f32 v[224:225], v[232:233], v[212:213], v[224:225] op_sel:[0,1,0] op_sel_hi:[1,1,1]
    v_pk_fma_f32 v[226:227], v[234:235], v[212:213], v[226:227] op_sel:[0,1,0] op_sel_hi:[1,1,1]
    v_pk_fma_f32 v[228:229], v[236:237], v[212:213], v[228:229] op_sel:[0,1,0] op_sel_hi:[1,1,1]
    v_pk_fma_f32 v[230:231], v[238:239], v[212:213], v[230:231] op_sel:[0,1,0] op_sel_hi:[1,1,1]
    s_waitcnt vmcnt(2)
    v_lshlrev_b32 v232, 16, v200
    v_and_b32 v233, 0xffff0000, v200
    v_lshlrev_b32 v234, 16, v201
    v_and_b32 v235, 0xffff0000, v201
    v_lshlrev_b32 v236, 16, v202
    v_and_b32 v237, 0xffff0000, v202
    v_lshlrev_b32 v238, 16, v203
    v_and_b32 v239, 0xffff0000, v203
    v_pk_fma_f32 v[224:225], v[232:233], v[214:215], v[224:225] op_sel:[0,0,0] op_sel_hi:[1,0,1]
    v_pk_fma_f32 v[226:227], v[234:235], v[214:215], v[226:227] op_sel:[0,0,0] op_sel_hi:[1,0,1]
    v_pk_fma_f32 v[228:229], v[236:237], v[214:215], v[228:229] op_sel:[0,0,0] op_sel_hi:[1,0,1]
    v_pk_fma_f32 v[230:231], v[238:239], v[214:215], v[230:231] op_sel:[0,0,0] op_sel_hi:[1,0,1]
    s_waitcnt vmcnt(1)
    v_lshlrev_b32 v232, 16, v204
    v_and_b32 v233, 0xffff0000, v204
    v_lshlrev_b32 v234, 16, v205
    v_and_b32 v235, 0xffff0000, v205
    v_lshlrev_b32 v236, 16, v206
    v_and_b32 v237, 0xffff0000, v206
    v_lshlrev_b32 v238, 16, v207
    v_and_b32 v239, 0xffff0000, v207
    v_pk_fma_f32 v[224:225], v[232:233], v[214:215], v[224:225] op_sel:[0,1,0] op_sel_hi:[1,1,1]
    v_pk_fma_f32 v[226:227], v[234:235], v[214:215], v[226:227] op_sel:[0,1,0] op_sel_hi:[1,1,1]
    v_pk_fma_f32 v[228:229], v[236:237], v[214:215], v[228:229] op_sel:[0,1,0] op_sel_hi:[1,1,1]
    v_pk_fma_f32 v[230:231], v[238:239], v[214:215], v[230:231] op_sel:[0,1,0] op_sel_hi:[1,1,1]
    s_nop 0
    v_permlane32_swap_b32 v224, v228
    v_permlane32_swap_b32 v225, v229
    v_permlane32_swap_b32 v226, v230
    v_permlane32_swap_b32 v227, v231
    v_add_f32 v224, v224, v228
    v_add_f32 v225, v225, v229
    v_add_f32 v226, v226, v230
    v_add_f32 v227, v227, v231
    s_nop 0
    v_permlane16_swap_b32 v224, v226
    v_permlane16_swap_b32 v225, v227
    v_add_f32 v224, v224, v226
    v_add_f32 v225, v225, v227
    s_nop 0
    v_add_f32_dpp v224, v224, v224 row_ror:8 row_mask:0xf bank_mask:0xf
    v_add_f32_dpp v225, v225, v225 row_ror:8 row_mask:0xf bank_mask:0xf
    v_mov_b32 v226, s92
    v_mov_b32 v227, s93
    s_mov_b32 exec_lo, 0x00ff00ff
    s_mov_b32 exec_hi, 0x00ff00ff
    buffer_store_dwordx4 v[224:227], v9, s[28:31], s53 offen sc1
    s_mov_b64 exec, -1
    s_barrier
    buffer_load_dwordx4 v[40:43], v16, s[36:39], s51 offen
    s_add_u32 s51, s51, 8192
    buffer_load_dwordx4 v[44:47], v17, s[36:39], s51 offen
    s_add_u32 s51, s51, 8192
    buffer_load_dwordx4 v[48:51], v16, s[36:39], s51 offen
    s_add_u32 s51, s51, 8192
    buffer_load_dwordx4 v[52:55], v17, s[36:39], s51 offen
    s_add_u32 s51, s51, 8192
    buffer_load_dwordx4 v[56:59], v16, s[36:39], s51 offen
    s_add_u32 s51, s51, 8192
    buffer_load_dwordx4 v[60:63], v17, s[36:39], s51 offen
    s_add_u32 s51, s51, 8192
    buffer_load_dwordx4 v[64:67], v16, s[36:39], s51 offen
    s_add_u32 s51, s51, 8192
    buffer_load_dwordx4 v[68:71], v17, s[36:39], s51 offen
    s_add_u32 s51, s51, 8192
    buffer_load_dwordx4 v[32:35], v16, s[36:39], s50 offen
    s_add_u32 s50, s50, 8192
    buffer_load_dwordx4 v[36:39], v17, s[36:39], s50 offen
    s_add_u32 s50, s50, 8192
    s_branch L_p1j
L_np2:
    s_waitcnt vmcnt(0)
    s_cmp_ge_u32 s26, 6
    s_cselect_b32 s52, 16, 0
    s_or_b32 s53, s101, s52
    s_xor_b32 s52, s52, 16
    s_or_b32 s52, s101, s52
    s_cmp_ge_u32 s53, 16
    s_cbranch_scc1 Lo_6
    s_barrier
Lo_6:
    buffer_load_dwordx4 v[40:43], v16, s[36:39], s51 offen
    s_add_u32 s51, s51, 8192
    buffer_load_dwordx4 v[44:47], v17, s[36:39], s51 offen
    s_add_u32 s51, s51, 8192
    buffer_load_dwordx4 v[48:51], v16, s[36:39], s51 offen
    s_add_u32 s51, s51, 8192
    buffer_load_dwordx4 v[52:55], v17, s[36:39], s51 offen
    s_add_u32 s51, s51, 8192
    buffer_load_dwordx4 v[56:59], v16, s[36:39], s51 offen
    s_add_u32 s51, s51, 8192
    buffer_load_dwordx4 v[60:63], v17, s[36:39], s51 offen
    s_add_u32 s51, s51, 8192
    buffer_load_dwordx4 v[64:67], v16, s[36:39], s51 offen
    s_add_u32 s51, s51, 8192
    buffer_load_dwordx4 v[68:71], v17, s[36:39], s51 offen
    s_add_u32 s51, s51, 8192
    buffer_load_dwordx4 v[32:35], v16, s[36:39], s50 offen
    s_add_u32 s50, s50, 8192
    buffer_load_dwordx4 v[36:39], v17, s[36:39], s50 offen
    s_add_u32 s50, s50, 8192
    s_cmp_ge_u32 s52, 16
    s_cbranch_scc1 Lo_7
    s_barrier
Lo_7:
L_p1j:
    s_cmp_lt_u32 s101, 16
    s_cbranch_scc1 Lo_8
    s_cmp_lg_u32 s26, 0
    s_cbranch_scc1 Lo_9
    s_and_b32 s86, s101, 15
    s_lshl_b32 s86, s86, 1
    s_lshl_b32 s10, s100, 4
    s_and_b32 s10, s10, 48
    s_xor_b32 s10, s10, s86
    s_mul_i32 s10, s10, 24576
    s_add_u32 s10, s6, s10
    s_addc_u32 s11, s7, 0
    s_mov_b32 exec_hi, 0xffff
    global_load_dword v15, v14, s[10:11]
    s_mov_b32 exec_hi, -1
Lo_9:
    s_cmp_lg_u32 s26, 0
    s_cbranch_scc1 Lo_10
    s_and_b32 s86, s101, 15
    s_lshl_b32 s86, s86, 1
    s_add_u32 s86, s86, 1
    s_lshl_b32 s10, s100, 4
    s_and_b32 s10, s10, 48
    s_xor_b32 s10, s10, s86
    s_mul_i32 s10, s10, 24576
    s_add_u32 s10, s6, s10
    s_addc_u32 s11, s7, 0
    s_mov_b32 exec_hi, 0xffff
    global_load_dword v15, v14, s[10:11]
    s_mov_b32 exec_hi, -1
Lo_10:
Lo_8:
    s_cmp_ge_u32 s101, 16
    s_cbranch_scc1 Lo_11
    s_cmp_lg_u32 s26, 5
    s_cbranch_scc1 Lo_12
    s_and_b32 s86, s101, 15
    s_lshl_b32 s86, s86, 1
    s_lshl_b32 s10, s100, 4
    s_and_b32 s10, s10, 48
    s_xor_b32 s10, s10, s86
    s_xor_b32 s10, s10, 32
    s_mul_i32 s10, s10, 24576
    s_add_u32 s10, s6, s10
    s_addc_u32 s11, s7, 0
    s_mov_b32 exec_hi, 0xffff
    global_load_dword v15, v14, s[10:11]
    s_mov_b32 exec_hi, -1
Lo_12:
    s_cmp_lg_u32 s26, 5
    s_cbranch_scc1 Lo_13
    s_and_b32 s86, s101, 15
    s_lshl_b32 s86, s86, 1
    s_add_u32 s86, s86, 1
    s_lshl_b32 s10, s100, 4
    s_and_b32 s10, s10, 48
    s_xor_b32 s10, s10, s86
    s_xor_b32 s10, s10, 32
    s_mul_i32 s10, s10, 24576
    s_add_u32 s10, s6, s10
    s_addc_u32 s11, s7, 0
    s_mov_b32 exec_hi, 0xffff
    global_load_dword v15, v14, s[10:11]
    s_mov_b32 exec_hi, -1
Lo_13:
Lo_11:
    s_cmp_ge_u32 s101, 16
    s_cbranch_scc1 Lo_14
    s_cmp_lg_u32 s26, 5
    s_cbranch_scc1 Lo_15
    s_and_b32 s86, s101, 15
    s_lshl_b32 s86, s86, 1
    s_lshl_b32 s10, s100, 4
    s_and_b32 s10, s10, 48
    s_xor_b32 s10, s10, s86
    s_mul_i32 s10, s10, 24576
    s_add_u32 s10, s10, 6144
    s_add_u32 s10, s6, s10
    s_addc_u32 s11, s7, 0
    s_mov_b32 exec_hi, 0xffff
    global_load_dword v15, v14, s[10:11]
    s_mov_b32 exec_hi, -1
Lo_15:
    s_cmp_lg_u32 s26, 5
    s_cbranch_scc1 Lo_16
    s_and_b32 s86, s101, 15
    s_lshl_b32 s86, s86, 1
    s_add_u32 s86, s86, 1
    s_lshl_b32 s10, s100, 4
    s_and_b32 s10, s10, 48
    s_xor_b32 s10, s10, s86
    s_mul_i32 s10, s10, 24576
    s_add_u32 s10, s10, 6144
    s_add_u32 s10, s6, s10
    s_addc_u32 s11, s7, 0
    s_mov_b32 exec_hi, 0xffff
    global_load_dword v15, v14, s[10:11]
    s_mov_b32 exec_hi, -1
Lo_16:
Lo_14:
    s_waitcnt vmcnt(9)
    v_dot2_f32_bf16 v154, v40, v31, 0
    v_dot2_f32_bf16 v164, v40, v40, 0
    v_dot2_f32_bf16 v154, v41, v31, v154
    v_dot2_f32_bf16 v164, v41, v41, v164
    v_dot2_f32_bf16 v154, v42, v31, v154
    v_dot2_f32_bf16 v164, v42, v42, v164
    v_dot2_f32_bf16 v154, v43, v31, v154
    v_dot2_f32_bf16 v164, v43, v43, v164
    v_lshlrev_b32 v88, 16, v40
    v_and_b32 v89, 0xffff0000, v40
    v_lshlrev_b32 v90, 16, v41
    v_and_b32 v91, 0xffff0000, v41
    v_lshlrev_b32 v92, 16, v42
    v_and_b32 v93, 0xffff0000, v42
    v_lshlrev_b32 v94, 16, v43
    v_and_b32 v95, 0xffff0000, v43
    s_waitcnt vmcnt(8)
    v_dot2_f32_bf16 v155, v44, v31, 0
    v_dot2_f32_bf16 v165, v44, v44, 0
    v_dot2_f32_bf16 v155, v45, v31, v155
    v_dot2_f32_bf16 v165, v45, v45, v165
    v_dot2_f32_bf16 v155, v46, v31, v155
    v_dot2_f32_bf16 v165, v46, v46, v165
    v_dot2_f32_bf16 v155, v47, v31, v155
    v_dot2_f32_bf16 v165, v47, v47, v165
    v_lshlrev_b32 v96, 16, v44
    v_and_b32 v97, 0xffff0000, v44
    v_lshlrev_b32 v98, 16, v45
    v_and_b32 v99, 0xffff0000, v45
    v_lshlrev_b32 v100, 16, v46
    v_and_b32 v101, 0xffff0000, v46
    v_lshlrev_b32 v102, 16, v47
    v_and_b32 v103, 0xffff0000, v47
    s_waitcnt vmcnt(7)
    v_dot2_f32_bf16 v156, v48, v31, 0
    v_dot2_f32_bf16 v166, v48, v48, 0
    v_dot2_f32_bf16 v156, v49, v31, v156
    v_dot2_f32_bf16 v166, v49, v49, v166
    v_dot2_f32_bf16 v156, v50, v31, v156
    v_dot2_f32_bf16 v166, v50, v50, v166
    v_dot2_f32_bf16 v156, v51, v31, v156
    v_dot2_f32_bf16 v166, v51, v51, v166
    v_lshlrev_b32 v104, 16, v48
    v_and_b32 v105, 0xffff0000, v48
    v_lshlrev_b32 v106, 16, v49
    v_and_b32 v107, 0xffff0000, v49
    v_lshlrev_b32 v108, 16, v50
    v_and_b32 v109, 0xffff0000, v50
    v_lshlrev_b32 v110, 16, v51
    v_and_b32 v111, 0xffff0000, v51
    s_waitcnt vmcnt(6)
    v_dot2_f32_bf16 v157, v52, v31, 0
    v_dot2_f32_bf16 v167, v52, v52, 0
    v_dot2_f32_bf16 v157, v53, v31, v157
    v_dot2_f32_bf16 v167, v53, v53, v167
    v_dot2_f32_bf16 v157, v54, v31, v157
    v_dot2_f32_bf16 v167, v54, v54, v167
    v_dot2_f32_bf16 v157, v55, v31, v157
    v_dot2_f32_bf16 v167, v55, v55, v167
    v_lshlrev_b32 v112, 16, v52
    v_and_b32 v113, 0xffff0000, v52
    v_lshlrev_b32 v114, 16, v53
    v_and_b32 v115, 0xffff0000, v53
    v_lshlrev_b32 v116, 16, v54
    v_and_b32 v117, 0xffff0000, v54
    v_lshlrev_b32 v118, 16, v55
    v_and_b32 v119, 0xffff0000, v55
    s_waitcnt vmcnt(5)
    v_dot2_f32_bf16 v158, v56, v31, 0
    v_dot2_f32_bf16 v168, v56, v56, 0
    v_dot2_f32_bf16 v158, v57, v31, v158
    v_dot2_f32_bf16 v168, v57, v57, v168
    v_dot2_f32_bf16 v158, v58, v31, v158
    v_dot2_f32_bf16 v168, v58, v58, v168
    v_dot2_f32_bf16 v158, v59, v31, v158
    v_dot2_f32_bf16 v168, v59, v59, v168
    v_lshlrev_b32 v120, 16, v56
    v_and_b32 v121, 0xffff0000, v56
    v_lshlrev_b32 v122, 16, v57
    v_and_b32 v123, 0xffff0000, v57
    v_lshlrev_b32 v124, 16, v58
    v_and_b32 v125, 0xffff0000, v58
    v_lshlrev_b32 v126, 16, v59
    v_and_b32 v127, 0xffff0000, v59
    s_waitcnt vmcnt(4)
    v_dot2_f32_bf16 v159, v60, v31, 0
    v_dot2_f32_bf16 v169, v60, v60, 0
    v_dot2_f32_bf16 v159, v61, v31, v159
    v_dot2_f32_bf16 v169, v61, v61, v169
    v_dot2_f32_bf16 v159, v62, v31, v159
    v_dot2_f32_bf16 v169, v62, v62, v169
    v_dot2_f32_bf16 v159, v63, v31, v159
    v_dot2_f32_bf16 v169, v63, v63, v169
    v_lshlrev_b32 v128, 16, v60
    v_and_b32 v129, 0xffff0000, v60
    v_lshlrev_b32 v130, 16, v61
    v_and_b32 v131, 0xffff0000, v61
    v_lshlrev_b32 v132, 16, v62
    v_and_b32 v133, 0xffff0000, v62
    v_lshlrev_b32 v134, 16, v63
    v_and_b32 v135, 0xffff0000, v63
    s_waitcnt vmcnt(3)
    v_dot2_f32_bf16 v160, v64, v31, 0
    v_dot2_f32_bf16 v170, v64, v64, 0
    v_dot2_f32_bf16 v160, v65, v31, v160
    v_dot2_f32_bf16 v170, v65, v65, v170
    v_dot2_f32_bf16 v160, v66, v31, v160
    v_dot2_f32_bf16 v170, v66, v66, v170
    v_dot2_f32_bf16 v160, v67, v31, v160
    v_dot2_f32_bf16 v170, v67, v67, v170
    v_lshlrev_b32 v136, 16, v64
    v_and_b32 v137, 0xffff0000, v64
    v_lshlrev_b32 v138, 16, v65
    v_and_b32 v139, 0xffff0000, v65
    v_lshlrev_b32 v140, 16, v66
    v_and_b32 v141, 0xffff0000, v66
    v_lshlrev_b32 v142, 16, v67
    v_and_b32 v143, 0xffff0000, v67
    s_waitcnt vmcnt(2)
    v_dot2_f32_bf16 v161, v68, v31, 0
    v_dot2_f32_bf16 v171, v68, v68, 0
    v_dot2_f32_bf16 v161, v69, v31, v161
    v_dot2_f32_bf16 v171, v69, v69, v171
    v_dot2_f32_bf16 v161, v70, v31, v161
    v_dot2_f32_bf16 v171, v70, v70, v171
    v_dot2_f32_bf16 v161, v71, v31, v161
    v_dot2_f32_bf16 v171, v71, v71, v171
    v_lshlrev_b32 v144, 16, v68
    v_and_b32 v145, 0xffff0000, v68
    v_lshlrev_b32 v146, 16, v69
    v_and_b32 v147, 0xffff0000, v69
    v_lshlrev_b32 v148, 16, v70
    v_and_b32 v149, 0xffff0000, v70
    v_lshlrev_b32 v150, 16, v71
    v_and_b32 v151, 0xffff0000, v71
    s_waitcnt vmcnt(1)
    v_dot2_f32_bf16 v152, v32, v31, 0
    v_dot2_f32_bf16 v162, v32, v32, 0
    v_dot2_f32_bf16 v152, v33, v31, v152
    v_dot2_f32_bf16 v162, v33, v33, v162
    v_dot2_f32_bf16 v152, v34, v31, v152
    v_dot2_f32_bf16 v162, v34, v34, v162
    v_dot2_f32_bf16 v152, v35, v31, v152
    v_dot2_f32_bf16 v162, v35, v35, v162
    v_lshlrev_b32 v72, 16, v32
    v_and_b32 v73, 0xffff0000, v32
    v_lshlrev_b32 v74, 16, v33
    v_and_b32 v75, 0xffff0000, v33
    v_lshlrev_b32 v76, 16, v34
    v_and_b32 v77, 0xffff0000, v34
    v_lshlrev_b32 v78, 16, v35
    v_and_b32 v79, 0xffff0000, v35
    s_waitcnt vmcnt(0)
    v_dot2_f32_bf16 v153, v36, v31, 0
    v_dot2_f32_bf16 v163, v36, v36, 0
    v_dot2_f32_bf16 v153, v37, v31, v153
    v_dot2_f32_bf16 v163, v37, v37, v163
    v_dot2_f32_bf16 v153, v38, v31, v153
    v_dot2_f32_bf16 v163, v38, v38, v163
    v_dot2_f32_bf16 v153, v39, v31, v153
    v_dot2_f32_bf16 v163, v39, v39, v163
    v_lshlrev_b32 v80, 16, v36
    v_and_b32 v81, 0xffff0000, v36
    v_lshlrev_b32 v82, 16, v37
    v_and_b32 v83, 0xffff0000, v37
    v_lshlrev_b32 v84, 16, v38
    v_and_b32 v85, 0xffff0000, v38
    v_lshlrev_b32 v86, 16, v39
    v_and_b32 v87, 0xffff0000, v39
    s_cmp_lg_u32 s26, 6
    s_cbranch_scc1 Lo_17
    global_load_dwordx2 v[172:173], v29, s[22:23] sc1
Lo_17:
    s_cmp_lg_u32 s49, 2
    s_cbranch_scc1 Lo_18
    s_lshl_b32 s54, s3, 12
    s_add_u32 s54, s54, 1572864
    s_cmp_ge_u32 s3, 8
    s_cselect_b32 s58, 1.0, 0
    v_lshlrev_b32 v5, 3, v1
    s_lshl_b32 s55, s3, 8
    s_add_u32 s55, s55, s97
    s_mov_b32 s59, 0
Lr_19:
    buffer_load_dwordx4 v[176:179], v2, s[28:31], s54 offen offset:0 sc1
    buffer_load_dwordx4 v[180:183], v2, s[28:31], s54 offen offset:1024 sc1
    buffer_load_dwordx4 v[184:187], v2, s[28:31], s54 offen offset:2048 sc1
    buffer_load_dwordx4 v[188:191], v2, s[28:31], s54 offen offset:3072 sc1
    s_add_u32 s59, s59, 1
    s_waitcnt vmcnt(0)
Lre_21:
    v_subrev_u32 v178, s94, v178
    v_subrev_u32 v182, s94, v182
    v_subrev_u32 v186, s94, v186
    v_subrev_u32 v190, s94, v190
    v_subrev_u32 v179, s95, v179
    v_subrev_u32 v183, s95, v183
    v_subrev_u32 v187, s95, v187
    v_subrev_u32 v191, s95, v191
    v_max3_u32 v178, v178, v182, v186
    v_max_u32 v178, v178, v190
    v_max3_u32 v179, v179, v183, v187
    v_max_u32 v179, v179, v191
    v_lshrrev_b32 v178, 15, v178
    v_max_u32 v178, v178, v179
    v_cmp_lt_u32 vcc, 1, v178
    v_pk_add_f32 v[176:177], v[176:177], v[180:181]
    v_pk_add_f32 v[184:185], v[184:185], v[188:189]
    s_cmp_gt_u32 s59, 200000
    s_cbranch_scc1 Lrd_20
    s_cbranch_vccz Lrd_20
    s_and_b32 s53, s59, 63
    s_cbranch_scc1 Lr_19
    global_load_dwordx2 v[10:11], v29, s[22:23] sc1
    s_waitcnt vmcnt(0)
    v_readfirstlane_b32 s56, v10
    v_readfirstlane_b32 s57, v11
    s_cmp_eq_u32 s56, 0
    s_cbranch_scc1 Lr_19
    s_lshr_b32 s57, s57, 16
    s_sub_u32 s94, s56, 1200
    s_subb_u32 s95, s57, 0
    s_lshr_b64 s[52:53], s[94:95], 16
    s_mov_b32 s95, s52
    s_branch Lr_19
Lrd_20:
    v_pk_add_f32 v[176:177], v[176:177], v[184:185]
    v_mov_b32 v178, v176
    v_mov_b32 v179, v177
    s_nop 0
    v_permlane32_swap_b32 v176, v178
    v_permlane32_swap_b32 v177, v179
    v_pk_add_f32 v[176:177], v[176:177], v[178:179]
    v_cvt_pk_bf16_f32 v176, v176, v177
    v_and_b32 v177, 0xffff0000, v176
    v_lshlrev_b32 v176, 16, v176
    v_add_f32 v176, s58, v176
    v_add_f32 v177, s58, v177
    v_cvt_pk_bf16_f32 v176, v176, v177
    v_mov_b32 v178, s92
    v_mov_b32 v179, s93
    v_mov_b32_dpp v177, v176 quad_perm:[1,0,3,2] row_mask:0xf bank_mask:0xf
    s_mov_b64 exec, 0x55555555
    s_add_u32 s54, s55, 8192
    buffer_store_dwordx4 v[176:179], v5, s[28:31], s54 offen
    buffer_store_dwordx4 v[176:179], v5, s[28:31], s55 offen sc1
    s_mov_b64 exec, -1
Lo_18:
    s_setprio 0
    v_permlane32_swap_b32 v152, v157
    v_permlane32_swap_b32 v162, v167
    v_permlane32_swap_b32 v153, v158
    v_permlane32_swap_b32 v163, v168
    v_permlane32_swap_b32 v154, v159
    v_permlane32_swap_b32 v164, v169
    v_permlane32_swap_b32 v155, v160
    v_permlane32_swap_b32 v165, v170
    v_permlane32_swap_b32 v156, v161
    v_permlane32_swap_b32 v166, v171
    v_add_f32 v152, v152, v157
    v_add_f32 v162, v162, v167
    v_add_f32 v153, v153, v158
    v_add_f32 v163, v163, v168
    v_add_f32 v154, v154, v159
    v_add_f32 v164, v164, v169
    v_add_f32 v155, v155, v160
    v_add_f32 v165, v165, v170
    v_add_f32 v156, v156, v161
    v_add_f32 v166, v166, v171
    v_mov_b32 v157, v156
    v_mov_b32 v167, v166
    v_permlane16_swap_b32 v152, v153
    v_permlane16_swap_b32 v162, v163
    v_permlane16_swap_b32 v154, v155
    v_permlane16_swap_b32 v164, v165
    v_permlane16_swap_b32 v156, v157
    v_permlane16_swap_b32 v166, v167
    v_add_f32 v152, v152, v153
    v_add_f32 v162, v162, v163
    v_add_f32 v154, v154, v155
    v_add_f32 v164, v164, v165
    v_add_f32 v156, v156, v157
    v_add_f32 v166, v166, v167
    v_add_f32_dpp v152, v152, v152 row_ror:8 row_mask:0xf bank_mask:0xf
    v_add_f32_dpp v162, v162, v162 row_ror:8 row_mask:0xf bank_mask:0xf
    v_add_f32_dpp v156, v156, v156 row_ror:8 row_mask:0xf bank_mask:0xf
    v_add_f32_dpp v166, v166, v166 row_ror:8 row_mask:0xf bank_mask:0xf
    v_add_f32_dpp v152, v154, v154 row_ror:8 row_mask:0xf bank_mask:0xc
    v_add_f32_dpp v162, v164, v164 row_ror:8 row_mask:0xf bank_mask:0xc
    v_add_f32_dpp v156, v156, v156 row_half_mirror row_mask:0xf bank_mask:0xf
    v_add_f32_dpp v166, v166, v166 row_half_mirror row_mask:0xf bank_mask:0xf
    s_nop 0
    v_add_f32_dpp v156, v152, v152 row_half_mirror row_mask:0xf bank_mask:0x5
    v_add_f32_dpp v166, v162, v162 row_half_mirror row_mask:0xf bank_mask:0x5
    s_nop 0
    v_add_f32_dpp v156, v156, v156 quad_perm:[1,0,3,2] row_mask:0xf bank_mask:0xf
    v_add_f32_dpp v166, v166, v166 quad_perm:[1,0,3,2] row_mask:0xf bank_mask:0xf
    s_nop 0
    v_add_f32_dpp v156, v156, v156 quad_perm:[2,3,0,1] row_mask:0xf bank_mask:0xf
    v_add_f32_dpp v166, v166, v166 quad_perm:[2,3,0,1] row_mask:0xf bank_mask:0xf
    v_mul_f32 v156, 0x3b000000, v156
    v_mul_f32 v166, 0x3b000000, v166
    v_fma_f32 v166, -v156, v156, v166
    v_max_f32 v166, 0, v166
    v_cvt_pk_bf16_f32 v166, v166, v166
    v_lshlrev_b32 v166, 16, v166
    v_add_f32 v166, 0x3727c5ac, v166
    v_cvt_pk_bf16_f32 v166, v166, v166
    v_lshlrev_b32 v166, 16, v166
    v_sqrt_f32 v166, v166
    v_cvt_pk_bf16_f32 v156, v156, v156
    v_lshlrev_b32 v156, 16, v156
    v_cvt_pk_bf16_f32 v166, v166, v166
    v_lshlrev_b32 v166, 16, v166
    v_rcp_f32 v166, v166
    s_nop 0
    v_mul_f32 v156, -v156, v166
    v_readlane_b32 s52, v166, 0
    v_readlane_b32 s53, v156, 0
    v_readlane_b32 s54, v166, 16
    v_readlane_b32 s55, v156, 16
    v_readlane_b32 s56, v166, 8
    v_readlane_b32 s57, v156, 8
    v_pk_fma_f32 v[72:73], v[72:73], s[52:53], s[52:53] op_sel:[0,0,1] op_sel_hi:[1,0,1]
    v_pk_fma_f32 v[74:75], v[74:75], s[52:53], s[52:53] op_sel:[0,0,1] op_sel_hi:[1,0,1]
    v_pk_fma_f32 v[76:77], v[76:77], s[52:53], s[52:53] op_sel:[0,0,1] op_sel_hi:[1,0,1]
    v_pk_fma_f32 v[78:79], v[78:79], s[52:53], s[52:53] op_sel:[0,0,1] op_sel_hi:[1,0,1]
    v_readlane_b32 s58, v166, 24
    v_readlane_b32 s59, v156, 24
    v_pk_fma_f32 v[80:81], v[80:81], s[54:55], s[54:55] op_sel:[0,0,1] op_sel_hi:[1,0,1]
    v_pk_fma_f32 v[82:83], v[82:83], s[54:55], s[54:55] op_sel:[0,0,1] op_sel_hi:[1,0,1]
    v_pk_fma_f32 v[84:85], v[84:85], s[54:55], s[54:55] op_sel:[0,0,1] op_sel_hi:[1,0,1]
    v_pk_fma_f32 v[86:87], v[86:87], s[54:55], s[54:55] op_sel:[0,0,1] op_sel_hi:[1,0,1]
    v_readlane_b32 s52, v166, 4
    v_readlane_b32 s53, v156, 4
    v_pk_fma_f32 v[88:89], v[88:89], s[56:57], s[56:57] op_sel:[0,0,1] op_sel_hi:[1,0,1]
    v_pk_fma_f32 v[90:91], v[90:91], s[56:57], s[56:57] op_sel:[0,0,1] op_sel_hi:[1,0,1]
    v_pk_fma_f32 v[92:93], v[92:93], s[56:57], s[56:57] op_sel:[0,0,1] op_sel_hi:[1,0,1]
    v_pk_fma_f32 v[94:95], v[94:95], s[56:57], s[56:57] op_sel:[0,0,1] op_sel_hi:[1,0,1]
    v_readlane_b32 s54, v166, 32
    v_readlane_b32 s55, v156, 32
    v_pk_fma_f32 v[96:97], v[96:97], s[58:59], s[58:59] op_sel:[0,0,1] op_sel_hi:[1,0,1]
    v_pk_fma_f32 v[98:99], v[98:99], s[58:59], s[58:59] op_sel:[0,0,1] op_sel_hi:[1,0,1]
    v_pk_fma_f32 v[100:101], v[100:101], s[58:59], s[58:59] op_sel:[0,0,1] op_sel_hi:[1,0,1]
    v_pk_fma_f32 v[102:103], v[102:103], s[58:59], s[58:59] op_sel:[0,0,1] op_sel_hi:[1,0,1]
    v_readlane_b32 s56, v166, 48
    v_readlane_b32 s57, v156, 48
    v_pk_fma_f32 v[104:105], v[104:105], s[52:53], s[52:53] op_sel:[0,0,1] op_sel_hi:[1,0,1]
    v_pk_fma_f32 v[106:107], v[106:107], s[52:53], s[52:53] op_sel:[0,0,1] op_sel_hi:[1,0,1]
    v_pk_fma_f32 v[108:109], v[108:109], s[52:53], s[52:53] op_sel:[0,0,1] op_sel_hi:[1,0,1]
    v_pk_fma_f32 v[110:111], v[110:111], s[52:53], s[52:53] op_sel:[0,0,1] op_sel_hi:[1,0,1]
    v_readlane_b32 s58, v166, 40
    v_readlane_b32 s59, v156, 40
    v_pk_fma_f32 v[112:113], v[112:113], s[54:55], s[54:55] op_sel:[0,0,1] op_sel_hi:[1,0,1]
    v_pk_fma_f32 v[114:115], v[114:115], s[54:55], s[54:55] op_sel:[0,0,1] op_sel_hi:[1,0,1]
    v_pk_fma_f32 v[116:117], v[116:117], s[54:55], s[54:55] op_sel:[0,0,1] op_sel_hi:[1,0,1]
    v_pk_fma_f32 v[118:119], v[118:119], s[54:55], s[54:55] op_sel:[0,0,1] op_sel_hi:[1,0,1]
    v_readlane_b32 s52, v166, 56
    v_readlane_b32 s53, v156, 56
    v_pk_fma_f32 v[120:121], v[120:121], s[56:57], s[56:57] op_sel:[0,0,1] op_sel_hi:[1,0,1]
    v_pk_fma_f32 v[122:123], v[122:123], s[56:57], s[56:57] op_sel:[0,0,1] op_sel_hi:[1,0,1]
    v_pk_fma_f32 v[124:125], v[124:125], s[56:57], s[56:57] op_sel:[0,0,1] op_sel_hi:[1,0,1]
    v_pk_fma_f32 v[126:127], v[126:127], s[56:57], s[56:57] op_sel:[0,0,1] op_sel_hi:[1,0,1]
    v_readlane_b32 s54, v166, 36
    v_readlane_b32 s55, v156, 36
    v_pk_fma_f32 v[128:129], v[128:129], s[58:59], s[58:59] op_sel:[0,0,1] op_sel_hi:[1,0,1]
    v_pk_fma_f32 v[130:131], v[130:131], s[58:59], s[58:59] op_sel:[0,0,1] op_sel_hi:[1,0,1]
    v_pk_fma_f32 v[132:133], v[132:133], s[58:59], s[58:59] op_sel:[0,0,1] op_sel_hi:[1,0,1]
    v_pk_fma_f32 v[134:135], v[134:135], s[58:59], s[58:59] op_sel:[0,0,1] op_sel_hi:[1,0,1]
    v_pk_fma_f32 v[136:137], v[136:137], s[52:53], s[52:53] op_sel:[0,0,1] op_sel_hi:[1,0,1]
    v_pk_fma_f32 v[138:139], v[138:139], s[52:53], s[52:53] op_sel:[0,0,1] op_sel_hi:[1,0,1]
    v_pk_fma_f32 v[140:141], v[140:141], s[52:53], s[52:53] op_sel:[0,0,1] op_sel_hi:[1,0,1]
    v_pk_fma_f32 v[142:143], v[142:143], s[52:53], s[52:53] op_sel:[0,0,1] op_sel_hi:[1,0,1]
    v_pk_fma_f32 v[144:145], v[144:145], s[54:55], s[54:55] op_sel:[0,0,1] op_sel_hi:[1,0,1]
    v_pk_fma_f32 v[146:147], v[146:147], s[54:55], s[54:55] op_sel:[0,0,1] op_sel_hi:[1,0,1]
    v_pk_fma_f32 v[148:149], v[148:149], s[54:55], s[54:55] op_sel:[0,0,1] op_sel_hi:[1,0,1]
    v_pk_fma_f32 v[150:151], v[150:151], s[54:55], s[54:55] op_sel:[0,0,1] op_sel_hi:[1,0,1]
    s_cmp_ge_u32 s26, 4
    s_cbranch_scc1 Lo_22
    v_and_b32 v4, 15, v1
    v_lshrrev_b32 v5, 4, v1
    v_mov_b32 v7, 0xf149f2ca
    v_lshlrev_b32 v8, 2, v5
    v_sub_u32 v8, v4, v8
    s_cmp_eq_u32 s44, 0
    s_cselect_b32 s52, 0, -1
    s_mov_b32 s53, 0
    s_cselect_b64 s[58:59], 0, -1
    v_subrev_u32 v9, 0, v8
    v_cmp_ge_u32 vcc, 7, v9
    v_cmp_ge_i32 s[54:55], -9, v9
    v_cmp_ge_i32 s[56:57], -1, v9
    v_cndmask_b32_e64 v224, v7, 0, vcc
    s_and_b64 s[56:57], s[56:57], s[52:53]
    v_cndmask_b32_e64 v228, v7, 0, s[54:55]
    v_cndmask_b32_e64 v232, v7, 0, s[56:57]
    v_cndmask_b32_e64 v236, v7, v228, s[58:59]
    v_subrev_u32 v9, 1, v8
    v_cmp_ge_u32 vcc, 7, v9
    v_cmp_ge_i32 s[54:55], -9, v9
    v_cmp_ge_i32 s[56:57], -1, v9
    v_cndmask_b32_e64 v225, v7, 0, vcc
    s_and_b64 s[56:57], s[56:57], s[52:53]
    v_cndmask_b32_e64 v229, v7, 0, s[54:55]
    v_cndmask_b32_e64 v233, v7, 0, s[56:57]
    v_cndmask_b32_e64 v237, v7, v229, s[58:59]
    v_subrev_u32 v9, 2, v8
    v_cmp_ge_u32 vcc, 7, v9
    v_cmp_ge_i32 s[54:55], -9, v9
    v_cmp_ge_i32 s[56:57], -1, v9
    v_cndmask_b32_e64 v226, v7, 0, vcc
    s_and_b64 s[56:57], s[56:57], s[52:53]
    v_cndmask_b32_e64 v230, v7, 0, s[54:55]
    v_cndmask_b32_e64 v234, v7, 0, s[56:57]
    v_cndmask_b32_e64 v238, v7, v230, s[58:59]
    v_subrev_u32 v9, 3, v8
    v_cmp_ge_u32 vcc, 7, v9
    v_cmp_ge_i32 s[54:55], -9, v9
    v_cmp_ge_i32 s[56:57], -1, v9
    v_cndmask_b32_e64 v227, v7, 0, vcc
    s_and_b64 s[56:57], s[56:57], s[52:53]
    v_cndmask_b32_e64 v231, v7, 0, s[54:55]
    v_cndmask_b32_e64 v235, v7, 0, s[56:57]
    v_cndmask_b32_e64 v239, v7, v231, s[58:59]
    v_and_b32 v8, 8, v1
    v_lshlrev_b32 v8, 8, v8
    v_sub_u32 v240, v22, v8
    v_sub_u32 v241, v23, v8
    v_sub_u32 v242, v24, v8
    v_sub_u32 v243, v25, v8
    s_lshl_b32 s49, s44, 16
    s_lshl_b32 s52, s45, 11
    s_add_u32 s49, s49, s52
    s_lshl_b32 s52, s27, 9
    s_add_u32 s49, s49, s52
    s_mul_i32 s52, s100, 655360
    s_add_u32 s49, s49, s52
    s_add_u32 s49, s49, 9437184
    s_add_u32 s51, s49, 32768
Lo_22:
    s_and_b32 s50, s26, 1
    s_lshl_b32 s50, s50, 11
    s_lshr_b32 s52, s26, 1
    s_lshl_b32 s52, s52, 8
    s_add_u32 s50, s50, s52
    v_add_u32 v28, s50, v13
    s_cmp_ge_u32 s26, 4
    s_cbranch_scc1 Lo_23
    s_waitcnt vmcnt(3)
    s_xor_b32 s53, s46, 0
    s_mul_i32 s53, s53, 393216
    s_add_u32 m0, s48, 81920
    s_add_u32 s53, s53, s47
    buffer_load_dwordx4 v3, s[32:35], s53 offen offset:0 lds
    buffer_load_dwordx4 v3, s[32:35], s53 offen offset:1024 lds
    buffer_load_dwordx4 v3, s[32:35], s53 offen offset:2048 lds
    s_waitcnt vmcnt(3)
    s_xor_b32 s53, s46, 1
    s_mul_i32 s53, s53, 393216
    s_add_u32 m0, s48, 94208
    s_add_u32 s53, s53, s47
    buffer_load_dwordx4 v3, s[32:35], s53 offen offset:0 lds
    buffer_load_dwordx4 v3, s[32:35], s53 offen offset:1024 lds
    buffer_load_dwordx4 v3, s[32:35], s53 offen offset:2048 lds
    s_waitcnt vmcnt(3)
    s_xor_b32 s53, s46, 2
    s_mul_i32 s53, s53, 393216
    s_add_u32 m0, s48, 106496
    s_add_u32 s53, s53, s47
    buffer_load_dwordx4 v3, s[32:35], s53 offen offset:0 lds
    buffer_load_dwordx4 v3, s[32:35], s53 offen offset:1024 lds
    buffer_load_dwordx4 v3, s[32:35], s53 offen offset:2048 lds
    s_waitcnt vmcnt(3)
    s_xor_b32 s53, s46, 3
    s_mul_i32 s53, s53, 393216
    s_add_u32 m0, s48, 118784
    s_add_u32 s53, s53, s47
    buffer_load_dwordx4 v3, s[32:35], s53 offen offset:0 lds
    buffer_load_dwordx4 v3, s[32:35], s53 offen offset:1024 lds
    buffer_load_dwordx4 v3, s[32:35], s53 offen offset:2048 lds
    s_waitcnt vmcnt(3)
    s_xor_b32 s53, s46, 0
    s_mul_i32 s53, s53, 393216
    s_add_u32 m0, s48, 131072
    s_add_u32 s53, s53, s47
    s_add_u32 s53, s53, 6144
    buffer_load_dwordx4 v3, s[32:35], s53 offen offset:0 lds
    buffer_load_dwordx4 v3, s[32:35], s53 offen offset:1024 lds
    buffer_load_dwordx4 v3, s[32:35], s53 offen offset:2048 lds
    s_waitcnt vmcnt(3)
    s_xor_b32 s53, s46, 1
    s_mul_i32 s53, s53, 393216
    s_add_u32 m0, s48, 143360
    s_add_u32 s53, s53, s47
    s_add_u32 s53, s53, 6144
    buffer_load_dwordx4 v3, s[32:35], s53 offen offset:0 lds
    buffer_load_dwordx4 v3, s[32:35], s53 offen offset:1024 lds
    buffer_load_dwordx4 v3, s[32:35], s53 offen offset:2048 lds
Lo_23:
    s_cmp_lg_u32 s26, 6
    s_cbranch_scc1 Lo_24
    v_lshlrev_b32 v5, 3, v1
    v_add_u32 v5, 159744, v5
    s_mov_b32 s59, 0
    s_add_u32 s58, s97, 8192
Lmf_27:
    buffer_load_dwordx4 v[152:155], v2, s[28:31], s58 offen offset:0 sc1
    buffer_load_dwordx4 v[156:159], v2, s[28:31], s58 offen offset:1024 sc1
    buffer_load_dwordx4 v[160:163], v2, s[28:31], s58 offen offset:2048 sc1
    buffer_load_dwordx4 v[164:167], v2, s[28:31], s58 offen offset:3072 sc1
    s_add_u32 s59, s59, 1
    s_waitcnt vmcnt(4)
    v_mov_b32 v168, v172
    v_mov_b32 v169, v173
    v_mov_b32 v170, v172
    s_waitcnt vmcnt(0)
    v_subrev_u32 v154, s94, v154
    v_subrev_u32 v158, s94, v158
    v_subrev_u32 v162, s94, v162
    v_subrev_u32 v166, s94, v166
    v_subrev_u32 v170, s94, v170
    v_subrev_u32 v155, s95, v155
    v_subrev_u32 v159, s95, v159
    v_subrev_u32 v163, s95, v163
    v_subrev_u32 v167, s95, v167
    v_subrev_u32 v169, s95, v169
    v_max3_u32 v154, v154, v158, v162
    v_max3_u32 v154, v154, v166, v170
    v_max3_u32 v155, v155, v159, v163
    v_max3_u32 v155, v155, v167, v169
    v_lshrrev_b32 v154, 15, v154
    v_max_u32 v154, v154, v155
    v_cmp_lt_u32 vcc, 1, v154
    s_cmp_ge_u32 s59, 8
    s_cbranch_vccz Lmd_26
    s_cbranch_scc1 Lm_25
    v_mov_b32 v169, v173
    v_mov_b32 v170, v172
    v_subrev_u32 v170, s94, v170
    v_subrev_u32 v169, s95, v169
    v_lshrrev_b32 v170, 15, v170
    v_max_u32 v170, v170, v169
    v_cmp_lt_u32 vcc, 1, v170
    s_cbranch_vccz Lmf_27
    global_load_dwordx2 v[172:173], v29, s[22:23] sc1
    s_branch Lmf_27
Lm_25:
    global_load_dwordx2 v[168:169], v29, s[22:23] sc1
    buffer_load_dwordx4 v[152:155], v2, s[28:31], s97 offen offset:0 sc1
    buffer_load_dwordx4 v[156:159], v2, s[28:31], s97 offen offset:1024 sc1
    buffer_load_dwordx4 v[160:163], v2, s[28:31], s97 offen offset:2048 sc1
    buffer_load_dwordx4 v[164:167], v2, s[28:31], s97 offen offset:3072 sc1
    s_add_u32 s59, s59, 1
    s_waitcnt vmcnt(4)
    v_mov_b32 v170, v168
    s_waitcnt vmcnt(0)
    v_subrev_u32 v154, s94, v154
    v_subrev_u32 v158, s94, v158
    v_subrev_u32 v162, s94, v162
    v_subrev_u32 v166, s94, v166
    v_subrev_u32 v170, s94, v170
    v_subrev_u32 v155, s95, v155
    v_subrev_u32 v159, s95, v159
    v_subrev_u32 v163, s95, v163
    v_subrev_u32 v167, s95, v167
    v_subrev_u32 v169, s95, v169
    v_max3_u32 v154, v154, v158, v162
    v_max3_u32 v154, v154, v166, v170
    v_max3_u32 v155, v155, v159, v163
    v_max3_u32 v155, v155, v167, v169
    v_lshrrev_b32 v154, 15, v154
    v_max_u32 v154, v154, v155
    v_cmp_lt_u32 vcc, 1, v154
    s_cmp_gt_u32 s59, 200000
    s_cbranch_scc1 Lmd_26
    s_cbranch_vccz Lmd_26
    s_and_b32 s53, s59, 63
    s_cbranch_scc1 Lm_25
    global_load_dwordx2 v[174:175], v29, s[22:23] sc1
    s_waitcnt vmcnt(0)
    v_readfirstlane_b32 s60, v174
    v_readfirstlane_b32 s61, v175
    s_cmp_eq_u32 s60, 0
    s_cbranch_scc1 Lm_25
    s_lshr_b32 s61, s61, 16
    s_sub_u32 s94, s60, 1200
    s_subb_u32 s95, s61, 0
    s_lshr_b64 s[52:53], s[94:95], 16
    s_mov_b32 s95, s52
    s_branch Lm_25
Lmd_26:
    ds_write_b64 v5, v[152:153] offset:0
    ds_write_b64 v5, v[156:157] offset:512
    ds_write_b64 v5, v[160:161] offset:1024
    ds_write_b64 v5, v[164:165] offset:1536
    ds_write_b32 v30, v168
    s_waitcnt lgkmcnt(0)
Lo_24:
    s_barrier
    ds_read_b128 v[200:203], v6 offset:0
    ds_read_b128 v[204:207], v6 offset:1024
    ds_read_b128 v[208:211], v18 offset:0
    ds_read_b128 v[212:215], v18 offset:1024
    ds_read_b32 v30, v30
    s_cmp_ge_u32 s26, 4
    s_cbranch_scc1 L_H
    s_setprio 1
    s_mov_b32 m0, s50
    s_waitcnt lgkmcnt(3)
    v_lshlrev_b32 v216, 16, v200
    v_and_b32 v217, 0xffff0000, v200
    v_lshlrev_b32 v218, 16, v204
    v_and_b32 v219, 0xffff0000, v204
    s_waitcnt lgkmcnt(1)
    v_lshlrev_b32 v220, 16, v208
    v_and_b32 v221, 0xffff0000, v208
    v_lshlrev_b32 v222, 16, v212
    v_and_b32 v223, 0xffff0000, v212
    v_pk_fma_f32 v[72:73], v[72:73], v[218:219], v[216:217]
    v_pk_fma_f32 v[80:81], v[80:81], v[222:223], v[220:221]
    v_pk_fma_f32 v[88:89], v[88:89], v[218:219], v[216:217]
    v_pk_fma_f32 v[96:97], v[96:97], v[222:223], v[220:221]
    v_pk_fma_f32 v[104:105], v[104:105], v[218:219], v[216:217]
    v_pk_fma_f32 v[112:113], v[112:113], v[222:223], v[220:221]
    v_pk_fma_f32 v[120:121], v[120:121], v[218:219], v[216:217]
    v_pk_fma_f32 v[128:129], v[128:129], v[222:223], v[220:221]
    v_pk_fma_f32 v[136:137], v[136:137], v[218:219], v[216:217]
    v_pk_fma_f32 v[144:145], v[144:145], v[222:223], v[220:221]
    v_cvt_pk_bf16_f32 v72, v72, v73
    v_cvt_pk_bf16_f32 v80, v80, v81
    ds_write_addtid_b32 v72 offset:0
    v_cvt_pk_bf16_f32 v88, v88, v89
    ds_write_addtid_b32 v80 offset:1024
    v_cvt_pk_bf16_f32 v96, v96, v97
    ds_write_addtid_b32 v88 offset:4096
    v_cvt_pk_bf16_f32 v104, v104, v105
    ds_write_addtid_b32 v96 offset:5120
    v_cvt_pk_bf16_f32 v112, v112, v113
    ds_write_addtid_b32 v104 offset:8192
    v_cvt_pk_bf16_f32 v120, v120, v121
    ds_write_addtid_b32 v112 offset:9216
    v_cvt_pk_bf16_f32 v128, v128, v129
    ds_write_addtid_b32 v120 offset:12288
    v_cvt_pk_bf16_f32 v136, v136, v137
    ds_write_addtid_b32 v128 offset:13312
    v_cvt_pk_bf16_f32 v144, v144, v145
    ds_write_addtid_b32 v136 offset:16384
    ds_write_addtid_b32 v144 offset:17408
    s_mov_b32 m0, s50
    v_lshlrev_b32 v216, 16, v201
    v_and_b32 v217, 0xffff0000, v201
    v_lshlrev_b32 v218, 16, v205
    v_and_b32 v219, 0xffff0000, v205
    v_lshlrev_b32 v220, 16, v209
    v_and_b32 v221, 0xffff0000, v209
    v_lshlrev_b32 v222, 16, v213
    v_and_b32 v223, 0xffff0000, v213
    v_pk_fma_f32 v[74:75], v[74:75], v[218:219], v[216:217]
    v_pk_fma_f32 v[82:83], v[82:83], v[222:223], v[220:221]
    v_pk_fma_f32 v[90:91], v[90:91], v[218:219], v[216:217]
    v_pk_fma_f32 v[98:99], v[98:99], v[222:223], v[220:221]
    v_pk_fma_f32 v[106:107], v[106:107], v[218:219], v[216:217]
    v_pk_fma_f32 v[114:115], v[114:115], v[222:223], v[220:221]
    v_pk_fma_f32 v[122:123], v[122:123], v[218:219], v[216:217]
    v_pk_fma_f32 v[130:131], v[130:131], v[222:223], v[220:221]
    v_pk_fma_f32 v[138:139], v[138:139], v[218:219], v[216:217]
    v_pk_fma_f32 v[146:147], v[146:147], v[222:223], v[220:221]
    v_cvt_pk_bf16_f32 v74, v74, v75
    v_cvt_pk_bf16_f32 v82, v82, v83
    ds_write_addtid_b32 v74 offset:20480
    v_cvt_pk_bf16_f32 v90, v90, v91
    ds_write_addtid_b32 v82 offset:21504
    v_cvt_pk_bf16_f32 v98, v98, v99
    ds_write_addtid_b32 v90 offset:24576
    v_cvt_pk_bf16_f32 v106, v106, v107
    ds_write_addtid_b32 v98 offset:25600
    v_cvt_pk_bf16_f32 v114, v114, v115
    ds_write_addtid_b32 v106 offset:28672
    v_cvt_pk_bf16_f32 v122, v122, v123
    ds_write_addtid_b32 v114 offset:29696
    v_cvt_pk_bf16_f32 v130, v130, v131
    ds_write_addtid_b32 v122 offset:32768
    v_cvt_pk_bf16_f32 v138, v138, v139
    ds_write_addtid_b32 v130 offset:33792
    v_cvt_pk_bf16_f32 v146, v146, v147
    ds_write_addtid_b32 v138 offset:36864
    ds_write_addtid_b32 v146 offset:37888
    s_add_u32 m0, s50, 40960
    v_lshlrev_b32 v216, 16, v202
    v_and_b32 v217, 0xffff0000, v202
    v_lshlrev_b32 v218, 16, v206
    v_and_b32 v219, 0xffff0000, v206
    v_lshlrev_b32 v220, 16, v210
    v_and_b32 v221, 0xffff0000, v210
    v_lshlrev_b32 v222, 16, v214
    v_and_b32 v223, 0xffff0000, v214
    v_pk_fma_f32 v[76:77], v[76:77], v[218:219], v[216:217]
    v_pk_fma_f32 v[84:85], v[84:85], v[222:223], v[220:221]
    v_pk_fma_f32 v[92:93], v[92:93], v[218:219], v[216:217]
    v_pk_fma_f32 v[100:101], v[100:101], v[222:223], v[220:221]
    v_pk_fma_f32 v[108:109], v[108:109], v[218:219], v[216:217]
    v_pk_fma_f32 v[116:117], v[116:117], v[222:223], v[220:221]
    v_pk_fma_f32 v[124:125], v[124:125], v[218:219], v[216:217]
    v_pk_fma_f32 v[132:133], v[132:133], v[222:223], v[220:221]
    v_pk_fma_f32 v[140:141], v[140:141], v[218:219], v[216:217]
    v_pk_fma_f32 v[148:149], v[148:149], v[222:223], v[220:221]
    v_cvt_pk_bf16_f32 v76, v76, v77
    v_cvt_pk_bf16_f32 v84, v84, v85
    ds_write_addtid_b32 v76 offset:0
    v_cvt_pk_bf16_f32 v92, v92, v93
    ds_write_addtid_b32 v84 offset:1024
    v_cvt_pk_bf16_f32 v100, v100, v101
    ds_write_addtid_b32 v92 offset:4096
    v_cvt_pk_bf16_f32 v108, v108, v109
    ds_write_addtid_b32 v100 offset:5120
    v_cvt_pk_bf16_f32 v116, v116, v117
    ds_write_addtid_b32 v108 offset:8192
    v_cvt_pk_bf16_f32 v124, v124, v125
    ds_write_addtid_b32 v116 offset:9216
    v_cvt_pk_bf16_f32 v132, v132, v133
    ds_write_addtid_b32 v124 offset:12288
    v_cvt_pk_bf16_f32 v140, v140, v141
    ds_write_addtid_b32 v132 offset:13312
    v_cvt_pk_bf16_f32 v148, v148, v149
    ds_write_addtid_b32 v140 offset:16384
    ds_write_addtid_b32 v148 offset:17408
    s_add_u32 m0, s50, 40960
    v_lshlrev_b32 v216, 16, v203
    v_and_b32 v217, 0xffff0000, v203
    v_lshlrev_b32 v218, 16, v207
    v_and_b32 v219, 0xffff0000, v207
    v_lshlrev_b32 v220, 16, v211
    v_and_b32 v221, 0xffff0000, v211
    v_lshlrev_b32 v222, 16, v215
    v_and_b32 v223, 0xffff0000, v215
    v_pk_fma_f32 v[78:79], v[78:79], v[218:219], v[216:217]
    v_pk_fma_f32 v[86:87], v[86:87], v[222:223], v[220:221]
    v_pk_fma_f32 v[94:95], v[94:95], v[218:219], v[216:217]
    v_pk_fma_f32 v[102:103], v[102:103], v[222:223], v[220:221]
    v_pk_fma_f32 v[110:111], v[110:111], v[218:219], v[216:217]
    v_pk_fma_f32 v[118:119], v[118:119], v[222:223], v[220:221]
    v_pk_fma_f32 v[126:127], v[126:127], v[218:219], v[216:217]
    v_pk_fma_f32 v[134:135], v[134:135], v[222:223], v[220:221]
    v_pk_fma_f32 v[142:143], v[142:143], v[218:219], v[216:217]
    v_pk_fma_f32 v[150:151], v[150:151], v[222:223], v[220:221]
    v_cvt_pk_bf16_f32 v78, v78, v79
    v_cvt_pk_bf16_f32 v86, v86, v87
    ds_write_addtid_b32 v78 offset:20480
    v_cvt_pk_bf16_f32 v94, v94, v95
    ds_write_addtid_b32 v86 offset:21504
    v_cvt_pk_bf16_f32 v102, v102, v103
    ds_write_addtid_b32 v94 offset:24576
    v_cvt_pk_bf16_f32 v110, v110, v111
    ds_write_addtid_b32 v102 offset:25600
    v_cvt_pk_bf16_f32 v118, v118, v119
    ds_write_addtid_b32 v110 offset:28672
    v_cvt_pk_bf16_f32 v126, v126, v127
    ds_write_addtid_b32 v118 offset:29696
    v_cvt_pk_bf16_f32 v134, v134, v135
    ds_write_addtid_b32 v126 offset:32768
    v_cvt_pk_bf16_f32 v142, v142, v143
    ds_write_addtid_b32 v134 offset:33792
    v_cvt_pk_bf16_f32 v150, v150, v151
    ds_write_addtid_b32 v142 offset:36864
    ds_write_addtid_b32 v150 offset:37888
    s_cmp_lg_u32 s26, 1
    s_cbranch_scc1 Lo_28
    s_waitcnt lgkmcnt(15)
    v_xor_b32 v11, s98, v30
    s_lshl_b32 s52, s101, 2
    s_add_u32 s52, s52, s96
    s_mov_b64 exec, 1
    buffer_store_dword v11, v13, s[28:31], s52 offen offset:512 sc1
    s_mov_b64 exec, -1
Lo_28:
    s_waitcnt vmcnt(12) lgkmcnt(0)
    s_barrier
    ds_read_b64_tr_b16 v[176:177], v26 offset:1024
    ds_read_b64_tr_b16 v[178:179], v26 offset:1536
    ds_read_b128 v[152:155], v240 offset:0
    ds_read_b64_tr_b16 v[180:181], v26 offset:2048
    ds_read_b64_tr_b16 v[182:183], v26 offset:2560
    ds_read_b128 v[156:159], v22 offset:4096
    ds_read_b64_tr_b16 v[172:173], v26 offset:0
    ds_read_b64_tr_b16 v[174:175], v26 offset:512
    ds_read_b128 v[160:163], v22 offset:6144
    ds_read_b128 v[164:167], v22 offset:12288
    ds_read_b128 v[168:171], v22 offset:14336
    s_waitcnt lgkmcnt(8)
    v_mfma_f32_16x16x32_bf16 v[48:51], v[176:179], v[152:155], 0
    ds_read_b64_tr_b16 v[208:209], v26 offset:13312
    ds_read_b64_tr_b16 v[210:211], v26 offset:13824
    s_waitcnt lgkmcnt(8)
    v_mfma_f32_16x16x32_bf16 v[68:71], v[152:155], v[180:183], 0
    ds_read_b128 v[184:187], v241 offset:0
    ds_read_b64_tr_b16 v[212:213], v26 offset:14336
    s_waitcnt lgkmcnt(9)
    v_mfma_f32_16x16x32_bf16 v[52:55], v[176:179], v[156:159], 0
    ds_read_b64_tr_b16 v[214:215], v26 offset:14848
    ds_read_b128 v[188:191], v23 offset:4096
    v_mfma_f32_16x16x32_bf16 v[72:75], v[156:159], v[180:183], 0
    ds_read_b64_tr_b16 v[204:205], v26 offset:12288
    ds_read_b64_tr_b16 v[206:207], v26 offset:12800
    s_waitcnt lgkmcnt(11)
    v_mfma_f32_16x16x32_bf16 v[32:35], v[172:175], v[156:159], 0
    ds_read_b128 v[192:195], v23 offset:6144
    ds_read_b128 v[196:199], v23 offset:12288
    s_waitcnt lgkmcnt(12)
    v_mfma_f32_16x16x32_bf16 v[56:59], v[176:179], v[160:163], 0
    ds_read_b128 v[200:203], v23 offset:14336
    v_mfma_f32_16x16x32_bf16 v[76:79], v[160:163], v[180:183], 0
    v_add_u32 v26, 0x6000, v26
    v_mfma_f32_16x16x32_bf16 v[36:39], v[172:175], v[160:163], 0
    s_waitcnt lgkmcnt(12)
    v_mfma_f32_16x16x32_bf16 v[60:63], v[176:179], v[164:167], 0
    v_mfma_f32_16x16x32_bf16 v[80:83], v[164:167], v[180:183], 0
    v_mfma_f32_16x16x32_bf16 v[40:43], v[172:175], v[164:167], 0
    s_waitcnt lgkmcnt(11)
    v_mfma_f32_16x16x32_bf16 v[64:67], v[176:179], v[168:171], 0
    v_mfma_f32_16x16x32_bf16 v[84:87], v[168:171], v[180:183], 0
    v_mfma_f32_16x16x32_bf16 v[44:47], v[172:175], v[168:171], 0
    s_waitcnt vmcnt(6) lgkmcnt(0)
    s_barrier
    v_mfma_f32_16x16x32_bf16 v[48:51], v[208:211], v[184:187], v[48:51]
    ds_read_b64_tr_b16 v[176:177], v26 offset:1024
    v_mfma_f32_16x16x32_bf16 v[68:71], v[184:187], v[212:215], v[68:71]
    ds_read_b64_tr_b16 v[178:179], v26 offset:1536
    v_mfma_f32_16x16x32_bf16 v[52:55], v[208:211], v[188:191], v[52:55]
    ds_read_b128 v[152:155], v242 offset:0
    v_mfma_f32_16x16x32_bf16 v[72:75], v[188:191], v[212:215], v[72:75]
    ds_read_b64_tr_b16 v[180:181], v26 offset:2048
    v_mfma_f32_16x16x32_bf16 v[32:35], v[204:207], v[188:191], v[32:35]
    ds_read_b64_tr_b16 v[182:183], v26 offset:2560
    v_mfma_f32_16x16x32_bf16 v[56:59], v[208:211], v[192:195], v[56:59]
    ds_read_b128 v[156:159], v24 offset:4096
    v_mfma_f32_16x16x32_bf16 v[76:79], v[192:195], v[212:215], v[76:79]
    ds_read_b64_tr_b16 v[172:173], v26 offset:0
    v_mfma_f32_16x16x32_bf16 v[36:39], v[204:207], v[192:195], v[36:39]
    ds_read_b64_tr_b16 v[174:175], v26 offset:512
    v_mfma_f32_16x16x32_bf16 v[60:63], v[208:211], v[196:199], v[60:63]
    ds_read_b128 v[160:163], v24 offset:6144
    v_mfma_f32_16x16x32_bf16 v[80:83], v[196:199], v[212:215], v[80:83]
    ds_read_b128 v[164:167], v24 offset:12288
    v_mfma_f32_16x16x32_bf16 v[40:43], v[204:207], v[196:199], v[40:43]
    ds_read_b128 v[168:171], v24 offset:14336
    v_mfma_f32_16x16x32_bf16 v[64:67], v[208:211], v[200:203], v[64:67]
    v_mfma_f32_16x16x32_bf16 v[84:87], v[200:203], v[212:215], v[84:87]
    v_mfma_f32_16x16x32_bf16 v[44:47], v[204:207], v[200:203], v[44:47]
    s_waitcnt lgkmcnt(8)
    v_mfma_f32_16x16x32_bf16 v[48:51], v[176:179], v[152:155], v[48:51]
    ds_read_b64_tr_b16 v[208:209], v26 offset:13312
    ds_read_b64_tr_b16 v[210:211], v26 offset:13824
    s_waitcnt lgkmcnt(8)
    v_mfma_f32_16x16x32_bf16 v[68:71], v[152:155], v[180:183], v[68:71]
    ds_read_b128 v[184:187], v243 offset:0
    ds_read_b64_tr_b16 v[212:213], v26 offset:14336
    s_waitcnt lgkmcnt(9)
    v_mfma_f32_16x16x32_bf16 v[52:55], v[176:179], v[156:159], v[52:55]
    ds_read_b64_tr_b16 v[214:215], v26 offset:14848
    ds_read_b128 v[188:191], v25 offset:4096
    v_mfma_f32_16x16x32_bf16 v[72:75], v[156:159], v[180:183], v[72:75]
    ds_read_b64_tr_b16 v[204:205], v26 offset:12288
    ds_read_b64_tr_b16 v[206:207], v26 offset:12800
    s_waitcnt lgkmcnt(11)
    v_mfma_f32_16x16x32_bf16 v[32:35], v[172:175], v[156:159], v[32:35]
    ds_read_b128 v[192:195], v25 offset:6144
    ds_read_b128 v[196:199], v25 offset:12288
    s_waitcnt lgkmcnt(12)
    v_mfma_f32_16x16x32_bf16 v[56:59], v[176:179], v[160:163], v[56:59]
    ds_read_b128 v[200:203], v25 offset:14336
    v_mfma_f32_16x16x32_bf16 v[76:79], v[160:163], v[180:183], v[76:79]
    v_add_u32 v26, 0x6000, v26
    v_mfma_f32_16x16x32_bf16 v[36:39], v[172:175], v[160:163], v[36:39]
    s_waitcnt lgkmcnt(12)
    v_mfma_f32_16x16x32_bf16 v[60:63], v[176:179], v[164:167], v[60:63]
    v_mfma_f32_16x16x32_bf16 v[80:83], v[164:167], v[180:183], v[80:83]
    v_mfma_f32_16x16x32_bf16 v[40:43], v[172:175], v[164:167], v[40:43]
    s_waitcnt lgkmcnt(11)
    v_mfma_f32_16x16x32_bf16 v[64:67], v[176:179], v[168:171], v[64:67]
    v_mfma_f32_16x16x32_bf16 v[84:87], v[168:171], v[180:183], v[84:87]
    v_mfma_f32_16x16x32_bf16 v[44:47], v[172:175], v[168:171], v[44:47]
    s_waitcnt vmcnt(0) lgkmcnt(0)
    s_barrier
    v_mfma_f32_16x16x32_bf16 v[48:51], v[208:211], v[184:187], v[48:51]
    ds_read_b64_tr_b16 v[176:177], v26 offset:1024
    v_mfma_f32_16x16x32_bf16 v[68:71], v[184:187], v[212:215], v[68:71]
    ds_read_b64_tr_b16 v[178:179], v26 offset:1536
    v_mfma_f32_16x16x32_bf16 v[52:55], v[208:211], v[188:191], v[52:55]
    ds_read_b128 v[152:155], v240 offset:20480
    v_mfma_f32_16x16x32_bf16 v[72:75], v[188:191], v[212:215], v[72:75]
    ds_read_b64_tr_b16 v[180:181], v26 offset:2048
    v_mfma_f32_16x16x32_bf16 v[32:35], v[204:207], v[188:191], v[32:35]
    ds_read_b64_tr_b16 v[182:183], v26 offset:2560
    v_mfma_f32_16x16x32_bf16 v[56:59], v[208:211], v[192:195], v[56:59]
    ds_read_b128 v[156:159], v22 offset:24576
    v_mfma_f32_16x16x32_bf16 v[76:79], v[192:195], v[212:215], v[76:79]
    ds_read_b64_tr_b16 v[172:173], v26 offset:0
    v_mfma_f32_16x16x32_bf16 v[36:39], v[204:207], v[192:195], v[36:39]
    ds_read_b64_tr_b16 v[174:175], v26 offset:512
    v_mfma_f32_16x16x32_bf16 v[60:63], v[208:211], v[196:199], v[60:63]
    ds_read_b128 v[160:163], v22 offset:26624
    v_mfma_f32_16x16x32_bf16 v[80:83], v[196:199], v[212:215], v[80:83]
    ds_read_b128 v[164:167], v22 offset:32768
    v_mfma_f32_16x16x32_bf16 v[40:43], v[204:207], v[196:199], v[40:43]
    ds_read_b128 v[168:171], v22 offset:34816
    v_mfma_f32_16x16x32_bf16 v[64:67], v[208:211], v[200:203], v[64:67]
    v_mfma_f32_16x16x32_bf16 v[84:87], v[200:203], v[212:215], v[84:87]
    v_mfma_f32_16x16x32_bf16 v[44:47], v[204:207], v[200:203], v[44:47]
    s_waitcnt lgkmcnt(8)
    v_mfma_f32_16x16x32_bf16 v[48:51], v[176:179], v[152:155], v[48:51]
    ds_read_b64_tr_b16 v[208:209], v26 offset:13312
    ds_read_b64_tr_b16 v[210:211], v26 offset:13824
    s_waitcnt lgkmcnt(8)
    v_mfma_f32_16x16x32_bf16 v[68:71], v[152:155], v[180:183], v[68:71]
    ds_read_b128 v[184:187], v241 offset:20480
    ds_read_b64_tr_b16 v[212:213], v26 offset:14336
    s_waitcnt lgkmcnt(9)
    v_mfma_f32_16x16x32_bf16 v[52:55], v[176:179], v[156:159], v[52:55]
    ds_read_b64_tr_b16 v[214:215], v26 offset:14848
    ds_read_b128 v[188:191], v23 offset:24576
    v_mfma_f32_16x16x32_bf16 v[72:75], v[156:159], v[180:183], v[72:75]
    ds_read_b64_tr_b16 v[204:205], v26 offset:12288
    ds_read_b64_tr_b16 v[206:207], v26 offset:12800
    s_waitcnt lgkmcnt(11)
    v_mfma_f32_16x16x32_bf16 v[32:35], v[172:175], v[156:159], v[32:35]
    ds_read_b128 v[192:195], v23 offset:26624
    ds_read_b128 v[196:199], v23 offset:32768
    s_waitcnt lgkmcnt(12)
    v_mfma_f32_16x16x32_bf16 v[56:59], v[176:179], v[160:163], v[56:59]
    ds_read_b128 v[200:203], v23 offset:34816
    v_mfma_f32_16x16x32_bf16 v[76:79], v[160:163], v[180:183], v[76:79]
    v_add_u32 v26, 0xffff4000, v26
    v_mfma_f32_16x16x32_bf16 v[36:39], v[172:175], v[160:163], v[36:39]
    s_waitcnt lgkmcnt(12)
    v_mfma_f32_16x16x32_bf16 v[60:63], v[176:179], v[164:167], v[60:63]
    v_mfma_f32_16x16x32_bf16 v[80:83], v[164:167], v[180:183], v[80:83]
    v_mfma_f32_16x16x32_bf16 v[40:43], v[172:175], v[164:167], v[40:43]
    s_waitcnt lgkmcnt(11)
    v_mfma_f32_16x16x32_bf16 v[64:67], v[176:179], v[168:171], v[64:67]
    v_mfma_f32_16x16x32_bf16 v[84:87], v[168:171], v[180:183], v[84:87]
    v_mfma_f32_16x16x32_bf16 v[44:47], v[172:175], v[168:171], v[44:47]
    s_waitcnt lgkmcnt(0)
    s_barrier
    v_mfma_f32_16x16x32_bf16 v[48:51], v[208:211], v[184:187], v[48:51]
    ds_read_b64_tr_b16 v[176:177], v26 offset:1024
    v_mfma_f32_16x16x32_bf16 v[68:71], v[184:187], v[212:215], v[68:71]
    ds_read_b64_tr_b16 v[178:179], v26 offset:1536
    v_mfma_f32_16x16x32_bf16 v[52:55], v[208:211], v[188:191], v[52:55]
    ds_read_b128 v[152:155], v242 offset:20480
    v_mfma_f32_16x16x32_bf16 v[72:75], v[188:191], v[212:215], v[72:75]
    ds_read_b64_tr_b16 v[180:181], v26 offset:2048
    v_mfma_f32_16x16x32_bf16 v[32:35], v[204:207], v[188:191], v[32:35]
    ds_read_b64_tr_b16 v[182:183], v26 offset:2560
    v_mfma_f32_16x16x32_bf16 v[56:59], v[208:211], v[192:195], v[56:59]
    ds_read_b128 v[156:159], v24 offset:24576
    v_mfma_f32_16x16x32_bf16 v[76:79], v[192:195], v[212:215], v[76:79]
    ds_read_b64_tr_b16 v[172:173], v26 offset:0
    v_mfma_f32_16x16x32_bf16 v[36:39], v[204:207], v[192:195], v[36:39]
    ds_read_b64_tr_b16 v[174:175], v26 offset:512
    v_mfma_f32_16x16x32_bf16 v[60:63], v[208:211], v[196:199], v[60:63]
    ds_read_b128 v[160:163], v24 offset:26624
    v_mfma_f32_16x16x32_bf16 v[80:83], v[196:199], v[212:215], v[80:83]
    ds_read_b128 v[164:167], v24 offset:32768
    v_mfma_f32_16x16x32_bf16 v[40:43], v[204:207], v[196:199], v[40:43]
    ds_read_b128 v[168:171], v24 offset:34816
    v_mfma_f32_16x16x32_bf16 v[64:67], v[208:211], v[200:203], v[64:67]
    v_mfma_f32_16x16x32_bf16 v[84:87], v[200:203], v[212:215], v[84:87]
    v_mfma_f32_16x16x32_bf16 v[44:47], v[204:207], v[200:203], v[44:47]
    s_waitcnt lgkmcnt(8)
    v_mfma_f32_16x16x32_bf16 v[48:51], v[176:179], v[152:155], v[48:51]
    ds_read_b64_tr_b16 v[208:209], v26 offset:13312
    ds_read_b64_tr_b16 v[210:211], v26 offset:13824
    s_waitcnt lgkmcnt(8)
    v_mfma_f32_16x16x32_bf16 v[68:71], v[152:155], v[180:183], v[68:71]
    ds_read_b128 v[184:187], v243 offset:20480
    ds_read_b64_tr_b16 v[212:213], v26 offset:14336
    s_waitcnt lgkmcnt(9)
    v_mfma_f32_16x16x32_bf16 v[52:55], v[176:179], v[156:159], v[52:55]
    ds_read_b64_tr_b16 v[214:215], v26 offset:14848
    ds_read_b128 v[188:191], v25 offset:24576
    v_mfma_f32_16x16x32_bf16 v[72:75], v[156:159], v[180:183], v[72:75]
    ds_read_b64_tr_b16 v[204:205], v26 offset:12288
    ds_read_b64_tr_b16 v[206:207], v26 offset:12800
    s_waitcnt lgkmcnt(11)
    v_mfma_f32_16x16x32_bf16 v[32:35], v[172:175], v[156:159], v[32:35]
    ds_read_b128 v[192:195], v25 offset:26624
    ds_read_b128 v[196:199], v25 offset:32768
    s_waitcnt lgkmcnt(12)
    v_mfma_f32_16x16x32_bf16 v[56:59], v[176:179], v[160:163], v[56:59]
    ds_read_b128 v[200:203], v25 offset:34816
    v_mfma_f32_16x16x32_bf16 v[76:79], v[160:163], v[180:183], v[76:79]
    v_add_u32 v26, 0x6000, v26
    v_mfma_f32_16x16x32_bf16 v[36:39], v[172:175], v[160:163], v[36:39]
    s_waitcnt lgkmcnt(12)
    v_mfma_f32_16x16x32_bf16 v[60:63], v[176:179], v[164:167], v[60:63]
    v_mfma_f32_16x16x32_bf16 v[80:83], v[164:167], v[180:183], v[80:83]
    v_mfma_f32_16x16x32_bf16 v[40:43], v[172:175], v[164:167], v[40:43]
    s_waitcnt lgkmcnt(11)
    v_mfma_f32_16x16x32_bf16 v[64:67], v[176:179], v[168:171], v[64:67]
    v_mfma_f32_16x16x32_bf16 v[84:87], v[168:171], v[180:183], v[84:87]
    v_mfma_f32_16x16x32_bf16 v[44:47], v[172:175], v[168:171], v[44:47]
    s_waitcnt lgkmcnt(0)
    s_barrier
    v_mfma_f32_16x16x32_bf16 v[48:51], v[208:211], v[184:187], v[48:51]
    ds_read_b64_tr_b16 v[176:177], v26 offset:1024
    v_mfma_f32_16x16x32_bf16 v[68:71], v[184:187], v[212:215], v[68:71]
    ds_read_b64_tr_b16 v[178:179], v26 offset:1536
    v_mfma_f32_16x16x32_bf16 v[52:55], v[208:211], v[188:191], v[52:55]
    ds_read_b128 v[152:155], v240 offset:40960
    v_mfma_f32_16x16x32_bf16 v[72:75], v[188:191], v[212:215], v[72:75]
    ds_read_b64_tr_b16 v[180:181], v26 offset:2048
    v_mfma_f32_16x16x32_bf16 v[32:35], v[204:207], v[188:191], v[32:35]
    ds_read_b64_tr_b16 v[182:183], v26 offset:2560
    v_mfma_f32_16x16x32_bf16 v[56:59], v[208:211], v[192:195], v[56:59]
    ds_read_b128 v[156:159], v22 offset:45056
    v_mfma_f32_16x16x32_bf16 v[76:79], v[192:195], v[212:215], v[76:79]
    ds_read_b64_tr_b16 v[172:173], v26 offset:0
    v_mfma_f32_16x16x32_bf16 v[36:39], v[204:207], v[192:195], v[36:39]
    ds_read_b64_tr_b16 v[174:175], v26 offset:512
    v_mfma_f32_16x16x32_bf16 v[60:63], v[208:211], v[196:199], v[60:63]
    ds_read_b128 v[160:163], v22 offset:47104
    v_mfma_f32_16x16x32_bf16 v[80:83], v[196:199], v[212:215], v[80:83]
    ds_read_b128 v[164:167], v22 offset:53248
    v_mfma_f32_16x16x32_bf16 v[40:43], v[204:207], v[196:199], v[40:43]
    ds_read_b128 v[168:171], v22 offset:55296
    v_mfma_f32_16x16x32_bf16 v[64:67], v[208:211], v[200:203], v[64:67]
    v_mfma_f32_16x16x32_bf16 v[84:87], v[200:203], v[212:215], v[84:87]
    v_mfma_f32_16x16x32_bf16 v[44:47], v[204:207], v[200:203], v[44:47]
    s_waitcnt lgkmcnt(8)
    v_mfma_f32_16x16x32_bf16 v[48:51], v[176:179], v[152:155], v[48:51]
    ds_read_b64_tr_b16 v[208:209], v26 offset:13312
    ds_read_b64_tr_b16 v[210:211], v26 offset:13824
    s_waitcnt lgkmcnt(8)
    v_mfma_f32_16x16x32_bf16 v[68:71], v[152:155], v[180:183], v[68:71]
    ds_read_b128 v[184:187], v241 offset:40960
    ds_read_b64_tr_b16 v[212:213], v26 offset:14336
    s_waitcnt lgkmcnt(9)
    v_mfma_f32_16x16x32_bf16 v[52:55], v[176:179], v[156:159], v[52:55]
    ds_read_b64_tr_b16 v[214:215], v26 offset:14848
    ds_read_b128 v[188:191], v23 offset:45056
    v_mfma_f32_16x16x32_bf16 v[72:75], v[156:159], v[180:183], v[72:75]
    ds_read_b64_tr_b16 v[204:205], v26 offset:12288
    ds_read_b64_tr_b16 v[206:207], v26 offset:12800
    s_waitcnt lgkmcnt(11)
    v_mfma_f32_16x16x32_bf16 v[32:35], v[172:175], v[156:159], v[32:35]
    ds_read_b128 v[192:195], v23 offset:47104
    ds_read_b128 v[196:199], v23 offset:53248
    s_waitcnt lgkmcnt(12)
    v_mfma_f32_16x16x32_bf16 v[56:59], v[176:179], v[160:163], v[56:59]
    ds_read_b128 v[200:203], v23 offset:55296
    v_mfma_f32_16x16x32_bf16 v[76:79], v[160:163], v[180:183], v[76:79]
    v_add_u32 v26, 0x6000, v26
    v_mfma_f32_16x16x32_bf16 v[36:39], v[172:175], v[160:163], v[36:39]
    s_waitcnt lgkmcnt(12)
    v_mfma_f32_16x16x32_bf16 v[60:63], v[176:179], v[164:167], v[60:63]
    v_mfma_f32_16x16x32_bf16 v[80:83], v[164:167], v[180:183], v[80:83]
    v_mfma_f32_16x16x32_bf16 v[40:43], v[172:175], v[164:167], v[40:43]
    s_waitcnt lgkmcnt(11)
    v_mfma_f32_16x16x32_bf16 v[64:67], v[176:179], v[168:171], v[64:67]
    v_mfma_f32_16x16x32_bf16 v[84:87], v[168:171], v[180:183], v[84:87]
    v_mfma_f32_16x16x32_bf16 v[44:47], v[172:175], v[168:171], v[44:47]
    s_waitcnt lgkmcnt(0)
    s_barrier
    v_mfma_f32_16x16x32_bf16 v[48:51], v[208:211], v[184:187], v[48:51]
    ds_read_b64_tr_b16 v[176:177], v26 offset:1024
    v_mfma_f32_16x16x32_bf16 v[68:71], v[184:187], v[212:215], v[68:71]
    ds_read_b64_tr_b16 v[178:179], v26 offset:1536
    v_mfma_f32_16x16x32_bf16 v[52:55], v[208:211], v[188:191], v[52:55]
    ds_read_b128 v[152:155], v242 offset:40960
    v_mfma_f32_16x16x32_bf16 v[72:75], v[188:191], v[212:215], v[72:75]
    ds_read_b64_tr_b16 v[180:181], v26 offset:2048
    v_mfma_f32_16x16x32_bf16 v[32:35], v[204:207], v[188:191], v[32:35]
    ds_read_b64_tr_b16 v[182:183], v26 offset:2560
    v_mfma_f32_16x16x32_bf16 v[56:59], v[208:211], v[192:195], v[56:59]
    ds_read_b128 v[156:159], v24 offset:45056
    v_mfma_f32_16x16x32_bf16 v[76:79], v[192:195], v[212:215], v[76:79]
    ds_read_b64_tr_b16 v[172:173], v26 offset:0
    v_mfma_f32_16x16x32_bf16 v[36:39], v[204:207], v[192:195], v[36:39]
    ds_read_b64_tr_b16 v[174:175], v26 offset:512
    v_mfma_f32_16x16x32_bf16 v[60:63], v[208:211], v[196:199], v[60:63]
    ds_read_b128 v[160:163], v24 offset:47104
    v_mfma_f32_16x16x32_bf16 v[80:83], v[196:199], v[212:215], v[80:83]
    ds_read_b128 v[164:167], v24 offset:53248
    v_mfma_f32_16x16x32_bf16 v[40:43], v[204:207], v[196:199], v[40:43]
    ds_read_b128 v[168:171], v24 offset:55296
    v_mfma_f32_16x16x32_bf16 v[64:67], v[208:211], v[200:203], v[64:67]
    v_mfma_f32_16x16x32_bf16 v[84:87], v[200:203], v[212:215], v[84:87]
    v_mfma_f32_16x16x32_bf16 v[44:47], v[204:207], v[200:203], v[44:47]
    s_waitcnt lgkmcnt(8)
    v_mfma_f32_16x16x32_bf16 v[48:51], v[176:179], v[152:155], v[48:51]
    ds_read_b64_tr_b16 v[208:209], v26 offset:13312
    ds_read_b64_tr_b16 v[210:211], v26 offset:13824
    s_waitcnt lgkmcnt(8)
    v_mfma_f32_16x16x32_bf16 v[68:71], v[152:155], v[180:183], v[68:71]
    ds_read_b128 v[184:187], v243 offset:40960
    ds_read_b64_tr_b16 v[212:213], v26 offset:14336
    s_waitcnt lgkmcnt(9)
    v_mfma_f32_16x16x32_bf16 v[52:55], v[176:179], v[156:159], v[52:55]
    ds_read_b64_tr_b16 v[214:215], v26 offset:14848
    ds_read_b128 v[188:191], v25 offset:45056
    v_mfma_f32_16x16x32_bf16 v[72:75], v[156:159], v[180:183], v[72:75]
    ds_read_b64_tr_b16 v[204:205], v26 offset:12288
    ds_read_b64_tr_b16 v[206:207], v26 offset:12800
    s_waitcnt lgkmcnt(11)
    v_mfma_f32_16x16x32_bf16 v[32:35], v[172:175], v[156:159], v[32:35]
    ds_read_b128 v[192:195], v25 offset:47104
    ds_read_b128 v[196:199], v25 offset:53248
    s_waitcnt lgkmcnt(12)
    v_mfma_f32_16x16x32_bf16 v[56:59], v[176:179], v[160:163], v[56:59]
    ds_read_b128 v[200:203], v25 offset:55296
    v_mfma_f32_16x16x32_bf16 v[76:79], v[160:163], v[180:183], v[76:79]
    v_add_u32 v26, 0xffff4000, v26
    v_mfma_f32_16x16x32_bf16 v[36:39], v[172:175], v[160:163], v[36:39]
    v_add_u32 v22, 61440, v22
    s_waitcnt lgkmcnt(12)
    v_mfma_f32_16x16x32_bf16 v[60:63], v[176:179], v[164:167], v[60:63]
    v_add_u32 v23, 61440, v23
    v_mfma_f32_16x16x32_bf16 v[80:83], v[164:167], v[180:183], v[80:83]
    v_add_u32 v240, 61440, v240
    v_mfma_f32_16x16x32_bf16 v[40:43], v[172:175], v[164:167], v[40:43]
    v_add_u32 v241, 61440, v241
    s_waitcnt lgkmcnt(11)
    v_mfma_f32_16x16x32_bf16 v[64:67], v[176:179], v[168:171], v[64:67]
    v_mfma_f32_16x16x32_bf16 v[84:87], v[168:171], v[180:183], v[84:87]
    v_mfma_f32_16x16x32_bf16 v[44:47], v[172:175], v[168:171], v[44:47]
    s_waitcnt lgkmcnt(0)
    s_barrier
    v_mfma_f32_16x16x32_bf16 v[48:51], v[208:211], v[184:187], v[48:51]
    ds_read_b64_tr_b16 v[176:177], v26 offset:1024
    v_mfma_f32_16x16x32_bf16 v[68:71], v[184:187], v[212:215], v[68:71]
    ds_read_b64_tr_b16 v[178:179], v26 offset:1536
    v_mfma_f32_16x16x32_bf16 v[52:55], v[208:211], v[188:191], v[52:55]
    ds_read_b128 v[152:155], v240 offset:0
    v_mfma_f32_16x16x32_bf16 v[72:75], v[188:191], v[212:215], v[72:75]
    ds_read_b64_tr_b16 v[180:181], v26 offset:2048
    v_mfma_f32_16x16x32_bf16 v[32:35], v[204:207], v[188:191], v[32:35]
    ds_read_b64_tr_b16 v[182:183], v26 offset:2560
    v_mfma_f32_16x16x32_bf16 v[56:59], v[208:211], v[192:195], v[56:59]
    ds_read_b128 v[156:159], v22 offset:4096
    v_mfma_f32_16x16x32_bf16 v[76:79], v[192:195], v[212:215], v[76:79]
    ds_read_b64_tr_b16 v[172:173], v26 offset:0
    v_mfma_f32_16x16x32_bf16 v[36:39], v[204:207], v[192:195], v[36:39]
    ds_read_b64_tr_b16 v[174:175], v26 offset:512
    v_mfma_f32_16x16x32_bf16 v[60:63], v[208:211], v[196:199], v[60:63]
    ds_read_b128 v[160:163], v22 offset:6144
    v_mfma_f32_16x16x32_bf16 v[80:83], v[196:199], v[212:215], v[80:83]
    ds_read_b128 v[164:167], v22 offset:12288
    v_mfma_f32_16x16x32_bf16 v[40:43], v[204:207], v[196:199], v[40:43]
    ds_read_b128 v[168:171], v22 offset:14336
    v_mfma_f32_16x16x32_bf16 v[64:67], v[208:211], v[200:203], v[64:67]
    v_mfma_f32_16x16x32_bf16 v[84:87], v[200:203], v[212:215], v[84:87]
    v_mfma_f32_16x16x32_bf16 v[44:47], v[204:207], v[200:203], v[44:47]
    s_waitcnt lgkmcnt(8)
    v_mfma_f32_16x16x32_bf16 v[48:51], v[176:179], v[152:155], v[48:51]
    ds_read_b64_tr_b16 v[208:209], v26 offset:13312
    ds_read_b64_tr_b16 v[210:211], v26 offset:13824
    s_waitcnt lgkmcnt(8)
    v_mfma_f32_16x16x32_bf16 v[68:71], v[152:155], v[180:183], v[68:71]
    ds_read_b128 v[184:187], v241 offset:0
    ds_read_b64_tr_b16 v[212:213], v26 offset:14336
    s_waitcnt lgkmcnt(9)
    v_mfma_f32_16x16x32_bf16 v[52:55], v[176:179], v[156:159], v[52:55]
    ds_read_b64_tr_b16 v[214:215], v26 offset:14848
    ds_read_b128 v[188:191], v23 offset:4096
    v_mfma_f32_16x16x32_bf16 v[72:75], v[156:159], v[180:183], v[72:75]
    ds_read_b64_tr_b16 v[204:205], v26 offset:12288
    ds_read_b64_tr_b16 v[206:207], v26 offset:12800
    s_waitcnt lgkmcnt(11)
    v_mfma_f32_16x16x32_bf16 v[32:35], v[172:175], v[156:159], v[32:35]
    ds_read_b128 v[192:195], v23 offset:6144
    ds_read_b128 v[196:199], v23 offset:12288
    s_waitcnt lgkmcnt(12)
    v_mfma_f32_16x16x32_bf16 v[56:59], v[176:179], v[160:163], v[56:59]
    ds_read_b128 v[200:203], v23 offset:14336
    v_mfma_f32_16x16x32_bf16 v[76:79], v[160:163], v[180:183], v[76:79]
    v_add_u32 v26, 0x6000, v26
    v_mfma_f32_16x16x32_bf16 v[36:39], v[172:175], v[160:163], v[36:39]
    v_add_u32 v24, 61440, v24
    s_waitcnt lgkmcnt(12)
    v_mfma_f32_16x16x32_bf16 v[60:63], v[176:179], v[164:167], v[60:63]
    v_add_u32 v25, 61440, v25
    v_mfma_f32_16x16x32_bf16 v[80:83], v[164:167], v[180:183], v[80:83]
    v_add_u32 v242, 61440, v242
    v_mfma_f32_16x16x32_bf16 v[40:43], v[172:175], v[164:167], v[40:43]
    v_add_u32 v243, 61440, v243
    s_waitcnt lgkmcnt(11)
    v_mfma_f32_16x16x32_bf16 v[64:67], v[176:179], v[168:171], v[64:67]
    v_mfma_f32_16x16x32_bf16 v[84:87], v[168:171], v[180:183], v[84:87]
    v_mfma_f32_16x16x32_bf16 v[44:47], v[172:175], v[168:171], v[44:47]
    s_waitcnt lgkmcnt(0)
    s_barrier
    v_mfma_f32_16x16x32_bf16 v[48:51], v[208:211], v[184:187], v[48:51]
    ds_read_b64_tr_b16 v[176:177], v26 offset:1024
    v_mfma_f32_16x16x32_bf16 v[68:71], v[184:187], v[212:215], v[68:71]
    ds_read_b64_tr_b16 v[178:179], v26 offset:1536
    v_mfma_f32_16x16x32_bf16 v[52:55], v[208:211], v[188:191], v[52:55]
    ds_read_b128 v[152:155], v242 offset:0
    v_mfma_f32_16x16x32_bf16 v[72:75], v[188:191], v[212:215], v[72:75]
    ds_read_b64_tr_b16 v[180:181], v26 offset:2048
    v_mfma_f32_16x16x32_bf16 v[32:35], v[204:207], v[188:191], v[32:35]
    ds_read_b64_tr_b16 v[182:183], v26 offset:2560
    v_mfma_f32_16x16x32_bf16 v[56:59], v[208:211], v[192:195], v[56:59]
    ds_read_b128 v[156:159], v24 offset:4096
    v_mfma_f32_16x16x32_bf16 v[76:79], v[192:195], v[212:215], v[76:79]
    ds_read_b64_tr_b16 v[172:173], v26 offset:0
    v_mfma_f32_16x16x32_bf16 v[36:39], v[204:207], v[192:195], v[36:39]
    ds_read_b64_tr_b16 v[174:175], v26 offset:512
    v_mfma_f32_16x16x32_bf16 v[60:63], v[208:211], v[196:199], v[60:63]
    ds_read_b128 v[160:163], v24 offset:6144
    v_mfma_f32_16x16x32_bf16 v[80:83], v[196:199], v[212:215], v[80:83]
    ds_read_b128 v[164:167], v24 offset:12288
    v_mfma_f32_16x16x32_bf16 v[40:43], v[204:207], v[196:199], v[40:43]
    ds_read_b128 v[168:171], v24 offset:14336
    v_mfma_f32_16x16x32_bf16 v[64:67], v[208:211], v[200:203], v[64:67]
    v_mfma_f32_16x16x32_bf16 v[84:87], v[200:203], v[212:215], v[84:87]
    v_mfma_f32_16x16x32_bf16 v[44:47], v[204:207], v[200:203], v[44:47]
    s_waitcnt lgkmcnt(8)
    v_mfma_f32_16x16x32_bf16 v[48:51], v[176:179], v[152:155], v[48:51]
    ds_read_b64_tr_b16 v[208:209], v26 offset:13312
    ds_read_b64_tr_b16 v[210:211], v26 offset:13824
    s_waitcnt lgkmcnt(8)
    v_mfma_f32_16x16x32_bf16 v[68:71], v[152:155], v[180:183], v[68:71]
    ds_read_b128 v[184:187], v243 offset:0
    ds_read_b64_tr_b16 v[212:213], v26 offset:14336
    s_waitcnt lgkmcnt(9)
    v_mfma_f32_16x16x32_bf16 v[52:55], v[176:179], v[156:159], v[52:55]
    ds_read_b64_tr_b16 v[214:215], v26 offset:14848
    ds_read_b128 v[188:191], v25 offset:4096
    v_mfma_f32_16x16x32_bf16 v[72:75], v[156:159], v[180:183], v[72:75]
    ds_read_b64_tr_b16 v[204:205], v26 offset:12288
    ds_read_b64_tr_b16 v[206:207], v26 offset:12800
    s_waitcnt lgkmcnt(11)
    v_mfma_f32_16x16x32_bf16 v[32:35], v[172:175], v[156:159], v[32:35]
    ds_read_b128 v[192:195], v25 offset:6144
    ds_read_b128 v[196:199], v25 offset:12288
    s_waitcnt lgkmcnt(12)
    v_mfma_f32_16x16x32_bf16 v[56:59], v[176:179], v[160:163], v[56:59]
    ds_read_b128 v[200:203], v25 offset:14336
    v_mfma_f32_16x16x32_bf16 v[76:79], v[160:163], v[180:183], v[76:79]
    v_mfma_f32_16x16x32_bf16 v[36:39], v[172:175], v[160:163], v[36:39]
    s_waitcnt lgkmcnt(12)
    v_mfma_f32_16x16x32_bf16 v[60:63], v[176:179], v[164:167], v[60:63]
    v_mfma_f32_16x16x32_bf16 v[80:83], v[164:167], v[180:183], v[80:83]
    v_mfma_f32_16x16x32_bf16 v[40:43], v[172:175], v[164:167], v[40:43]
    s_waitcnt lgkmcnt(11)
    v_mfma_f32_16x16x32_bf16 v[64:67], v[176:179], v[168:171], v[64:67]
    v_mfma_f32_16x16x32_bf16 v[84:87], v[168:171], v[180:183], v[84:87]
    v_mfma_f32_16x16x32_bf16 v[44:47], v[172:175], v[168:171], v[44:47]
    s_waitcnt lgkmcnt(0)
    s_barrier
    v_mfma_f32_16x16x32_bf16 v[48:51], v[208:211], v[184:187], v[48:51]
    v_mfma_f32_16x16x32_bf16 v[68:71], v[184:187], v[212:215], v[68:71]
    v_mfma_f32_16x16x32_bf16 v[52:55], v[208:211], v[188:191], v[52:55]
    v_mfma_f32_16x16x32_bf16 v[72:75], v[188:191], v[212:215], v[72:75]
    v_mfma_f32_16x16x32_bf16 v[32:35], v[204:207], v[188:191], v[32:35]
    v_mfma_f32_16x16x32_bf16 v[56:59], v[208:211], v[192:195], v[56:59]
    v_mfma_f32_16x16x32_bf16 v[76:79], v[192:195], v[212:215], v[76:79]
    v_mfma_f32_16x16x32_bf16 v[36:39], v[204:207], v[192:195], v[36:39]
    v_mfma_f32_16x16x32_bf16 v[60:63], v[208:211], v[196:199], v[60:63]
    v_mfma_f32_16x16x32_bf16 v[80:83], v[196:199], v[212:215], v[80:83]
    v_mfma_f32_16x16x32_bf16 v[40:43], v[204:207], v[196:199], v[40:43]
    v_mfma_f32_16x16x32_bf16 v[64:67], v[208:211], v[200:203], v[64:67]
    v_mfma_f32_16x16x32_bf16 v[84:87], v[200:203], v[212:215], v[84:87]
    v_mfma_f32_16x16x32_bf16 v[44:47], v[204:207], v[200:203], v[44:47]
    v_cvt_pk_bf16_f32 v88, v32, v33
    v_cvt_pk_bf16_f32 v89, v34, v35
    v_cvt_pk_bf16_f32 v90, v36, v37
    v_cvt_pk_bf16_f32 v91, v38, v39
    s_nop 0
    v_cvt_pk_bf16_f32 v92, v40, v41
    v_cvt_pk_bf16_f32 v93, v42, v43
    s_nop 0
    v_cvt_pk_bf16_f32 v94, v44, v45
    v_cvt_pk_bf16_f32 v95, v46, v47
    v_cvt_pk_bf16_f32 v96, v48, v49
    v_cvt_pk_bf16_f32 v97, v50, v51
    v_cvt_pk_bf16_f32 v98, v52, v53
    v_cvt_pk_bf16_f32 v99, v54, v55
    v_cvt_pk_bf16_f32 v100, v56, v57
    v_cvt_pk_bf16_f32 v101, v58, v59
    v_cvt_pk_bf16_f32 v102, v60, v61
    v_cvt_pk_bf16_f32 v103, v62, v63
    v_cvt_pk_bf16_f32 v104, v64, v65
    v_cvt_pk_bf16_f32 v105, v66, v67
    v_mfma_f32_16x16x16_bf16 v[124:127], v[96:97], v[88:89], v[232:235]
    v_mfma_f32_16x16x16_bf16 v[128:131], v[98:99], v[88:89], v[224:227]
    v_mfma_f32_16x16x16_bf16 v[132:135], v[96:97], v[90:91], v[236:239]
    v_mfma_f32_16x16x16_bf16 v[136:139], v[100:101], v[90:91], v[224:227]
    v_mfma_f32_16x16x16_bf16 v[140:143], v[98:99], v[92:93], v[228:231]
    v_mfma_f32_16x16x16_bf16 v[144:147], v[102:103], v[92:93], v[224:227]
    v_mfma_f32_16x16x16_bf16 v[148:151], v[100:101], v[94:95], v[228:231]
    v_mfma_f32_16x16x16_bf16 v[152:155], v[104:105], v[94:95], v[224:227]
    v_cvt_pk_bf16_f32 v108, v68, v69
    v_cvt_pk_bf16_f32 v109, v70, v71
    v_cvt_pk_bf16_f32 v110, v72, v73
    v_cvt_pk_bf16_f32 v111, v74, v75
    v_cvt_pk_bf16_f32 v112, v68, v69
    v_cvt_pk_bf16_f32 v113, v70, v71
    v_cvt_pk_bf16_f32 v114, v76, v77
    v_cvt_pk_bf16_f32 v115, v78, v79
    v_cvt_pk_bf16_f32 v116, v72, v73
    v_cvt_pk_bf16_f32 v117, v74, v75
    v_cvt_pk_bf16_f32 v118, v80, v81
    v_cvt_pk_bf16_f32 v119, v82, v83
    v_cvt_pk_bf16_f32 v120, v76, v77
    v_cvt_pk_bf16_f32 v121, v78, v79
    v_cvt_pk_bf16_f32 v122, v84, v85
    v_cvt_pk_bf16_f32 v123, v86, v87
    s_mov_b32 s56, 0x3eb8aa3b
    v_max3_f32 v156, v124, v125, v126
    v_max3_f32 v157, v127, v128, v129
    v_max3_f32 v156, v156, v130, v131
    v_max_f32 v156, v156, v157
    v_max3_f32 v160, v132, v133, v134
    v_max3_f32 v161, v135, v136, v137
    v_max3_f32 v160, v160, v138, v139
    v_max_f32 v160, v160, v161
    v_max3_f32 v164, v140, v141, v142
    v_max3_f32 v165, v143, v144, v145
    v_max3_f32 v164, v164, v146, v147
    v_max_f32 v164, v164, v165
    v_max3_f32 v168, v148, v149, v150
    v_max3_f32 v169, v151, v152, v153
    v_max3_f32 v168, v168, v154, v155
    v_max_f32 v168, v168, v169
    v_mov_b32 v157, v156
    v_mov_b32 v161, v160
    v_mov_b32 v165, v164
    v_mov_b32 v169, v168
    v_permlane16_swap_b32 v156, v157
    v_permlane16_swap_b32 v160, v161
    v_permlane16_swap_b32 v164, v165
    v_permlane16_swap_b32 v168, v169
    v_max_f32 v156, v156, v157
    v_max_f32 v160, v160, v161
    v_max_f32 v164, v164, v165
    v_max_f32 v168, v168, v169
    v_mov_b32 v157, v156
    v_mov_b32 v161, v160
    v_mov_b32 v165, v164
    v_mov_b32 v169, v168
    v_permlane32_swap_b32 v156, v157
    v_permlane32_swap_b32 v160, v161
    v_permlane32_swap_b32 v164, v165
    v_permlane32_swap_b32 v168, v169
    v_max_f32 v156, v156, v157
    v_max_f32 v160, v160, v161
    v_max_f32 v164, v164, v165
    v_max_f32 v168, v168, v169
    v_mul_f32 v156, s56, v156
    v_fma_f32 v124, v124, s56, -v156
    v_fma_f32 v125, v125, s56, -v156
    v_fma_f32 v126, v126, s56, -v156
    v_fma_f32 v127, v127, s56, -v156
    v_fma_f32 v128, v128, s56, -v156
    v_fma_f32 v129, v129, s56, -v156
    v_fma_f32 v130, v130, s56, -v156
    v_fma_f32 v131, v131, s56, -v156
    v_mul_f32 v160, s56, v160
    v_fma_f32 v132, v132, s56, -v160
    v_fma_f32 v133, v133, s56, -v160
    v_fma_f32 v134, v134, s56, -v160
    v_fma_f32 v135, v135, s56, -v160
    v_fma_f32 v136, v136, s56, -v160
    v_fma_f32 v137, v137, s56, -v160
    v_fma_f32 v138, v138, s56, -v160
    v_fma_f32 v139, v139, s56, -v160
    v_mul_f32 v164, s56, v164
    v_fma_f32 v140, v140, s56, -v164
    v_fma_f32 v141, v141, s56, -v164
    v_fma_f32 v142, v142, s56, -v164
    v_fma_f32 v143, v143, s56, -v164
    v_fma_f32 v144, v144, s56, -v164
    v_fma_f32 v145, v145, s56, -v164
    v_fma_f32 v146, v146, s56, -v164
    v_fma_f32 v147, v147, s56, -v164
    v_mul_f32 v168, s56, v168
    v_fma_f32 v148, v148, s56, -v168
    v_fma_f32 v149, v149, s56, -v168
    v_fma_f32 v150, v150, s56, -v168
    v_fma_f32 v151, v151, s56, -v168
    v_fma_f32 v152, v152, s56, -v168
    v_fma_f32 v153, v153, s56, -v168
    v_fma_f32 v154, v154, s56, -v168
    v_fma_f32 v155, v155, s56, -v168
    v_exp_f32 v124, v124
    v_exp_f32 v125, v125
    v_exp_f32 v126, v126
    v_exp_f32 v127, v127
    v_exp_f32 v128, v128
    v_exp_f32 v129, v129
    v_exp_f32 v130, v130
    v_exp_f32 v131, v131
    v_exp_f32 v132, v132
    v_exp_f32 v133, v133
    v_exp_f32 v134, v134
    v_exp_f32 v135, v135
    v_exp_f32 v136, v136
    v_exp_f32 v137, v137
    v_exp_f32 v138, v138
    v_exp_f32 v139, v139
    v_exp_f32 v140, v140
    v_exp_f32 v141, v141
    v_exp_f32 v142, v142
    v_exp_f32 v143, v143
    v_exp_f32 v144, v144
    v_exp_f32 v145, v145
    v_exp_f32 v146, v146
    v_exp_f32 v147, v147
    v_exp_f32 v148, v148
    v_exp_f32 v149, v149
    v_exp_f32 v150, v150
    v_exp_f32 v151, v151
    v_exp_f32 v152, v152
    v_exp_f32 v153, v153
    v_exp_f32 v154, v154
    v_exp_f32 v155, v155
    v_add_f32 v156, v124, v125
    v_add_f32 v157, v126, v127
    v_add_f32 v158, v128, v129
    v_add_f32 v159, v130, v131
    v_add_f32 v156, v156, v157
    v_add_f32 v158, v158, v159
    v_add_f32 v156, v156, v158
    v_add_f32 v160, v132, v133
    v_add_f32 v161, v134, v135
    v_add_f32 v162, v136, v137
    v_add_f32 v163, v138, v139
    v_add_f32 v160, v160, v161
    v_add_f32 v162, v162, v163
    v_add_f32 v160, v160, v162
    v_add_f32 v164, v140, v141
    v_add_f32 v165, v142, v143
    v_add_f32 v166, v144, v145
    v_add_f32 v167, v146, v147
    v_add_f32 v164, v164, v165
    v_add_f32 v166, v166, v167
    v_add_f32 v164, v164, v166
    v_add_f32 v168, v148, v149
    v_add_f32 v169, v150, v151
    v_add_f32 v170, v152, v153
    v_add_f32 v171, v154, v155
    v_add_f32 v168, v168, v169
    v_add_f32 v170, v170, v171
    v_add_f32 v168, v168, v170
    v_mov_b32 v157, v156
    v_mov_b32 v161, v160
    v_mov_b32 v165, v164
    v_mov_b32 v169, v168
    v_permlane16_swap_b32 v156, v157
    v_permlane16_swap_b32 v160, v161
    v_permlane16_swap_b32 v164, v165
    v_permlane16_swap_b32 v168, v169
    v_add_f32 v156, v156, v157
    v_add_f32 v160, v160, v161
    v_add_f32 v164, v164, v165
    v_add_f32 v168, v168, v169
    v_mov_b32 v157, v156
    v_mov_b32 v161, v160
    v_mov_b32 v165, v164
    v_mov_b32 v169, v168
    v_permlane32_swap_b32 v156, v157
    v_permlane32_swap_b32 v160, v161
    v_permlane32_swap_b32 v164, v165
    v_permlane32_swap_b32 v168, v169
    v_add_f32 v156, v156, v157
    v_add_f32 v160, v160, v161
    v_add_f32 v164, v164, v165
    v_add_f32 v168, v168, v169
    v_rcp_f32 v156, v156
    v_rcp_f32 v160, v160
    v_rcp_f32 v164, v164
    v_rcp_f32 v168, v168
    s_barrier
    v_mul_f32 v124, v124, v156
    v_mul_f32 v125, v125, v156
    v_mul_f32 v126, v126, v156
    v_mul_f32 v127, v127, v156
    v_mul_f32 v128, v128, v156
    v_mul_f32 v129, v129, v156
    v_mul_f32 v130, v130, v156
    v_mul_f32 v131, v131, v156
    v_cvt_pk_bf16_f32 v172, v124, v125
    v_cvt_pk_bf16_f32 v173, v126, v127
    v_cvt_pk_bf16_f32 v174, v128, v129
    v_cvt_pk_bf16_f32 v175, v130, v131
    s_nop 1
    v_mfma_f32_16x16x32_bf16 v[188:191], v[108:111], v[172:175], 0
    v_mul_f32 v132, v132, v160
    v_mul_f32 v133, v133, v160
    v_mul_f32 v134, v134, v160
    v_mul_f32 v135, v135, v160
    v_mul_f32 v136, v136, v160
    v_mul_f32 v137, v137, v160
    v_mul_f32 v138, v138, v160
    v_mul_f32 v139, v139, v160
    v_cvt_pk_bf16_f32 v176, v132, v133
    v_cvt_pk_bf16_f32 v177, v134, v135
    v_cvt_pk_bf16_f32 v178, v136, v137
    v_cvt_pk_bf16_f32 v179, v138, v139
    s_nop 1
    v_mfma_f32_16x16x32_bf16 v[192:195], v[112:115], v[176:179], 0
    v_mul_f32 v140, v140, v164
    v_mul_f32 v141, v141, v164
    v_mul_f32 v142, v142, v164
    v_mul_f32 v143, v143, v164
    v_mul_f32 v144, v144, v164
    v_mul_f32 v145, v145, v164
    v_mul_f32 v146, v146, v164
    v_mul_f32 v147, v147, v164
    v_cvt_pk_bf16_f32 v180, v140, v141
    v_cvt_pk_bf16_f32 v181, v142, v143
    v_cvt_pk_bf16_f32 v182, v144, v145
    v_cvt_pk_bf16_f32 v183, v146, v147
    s_nop 1
    v_mfma_f32_16x16x32_bf16 v[196:199], v[116:119], v[180:183], 0
    v_mul_f32 v148, v148, v168
    v_mul_f32 v149, v149, v168
    v_mul_f32 v150, v150, v168
    v_mul_f32 v151, v151, v168
    v_mul_f32 v152, v152, v168
    v_mul_f32 v153, v153, v168
    v_mul_f32 v154, v154, v168
    v_mul_f32 v155, v155, v168
    v_cvt_pk_bf16_f32 v184, v148, v149
    v_cvt_pk_bf16_f32 v185, v150, v151
    v_cvt_pk_bf16_f32 v186, v152, v153
    v_cvt_pk_bf16_f32 v187, v154, v155
    s_nop 1
    v_mfma_f32_16x16x32_bf16 v[200:203], v[120:123], v[184:187], 0
    v_cvt_pk_bf16_f32 v128, v188, v189
    v_cvt_pk_bf16_f32 v129, v190, v191
    v_cvt_pk_bf16_f32 v130, v192, v193
    v_cvt_pk_bf16_f32 v131, v194, v195
    s_nop 0
    v_permlane32_swap_b32 v128, v130
    v_permlane32_swap_b32 v129, v131
    buffer_store_dwordx4 v[128:131], v27, s[28:31], s49 offen sc1
    v_cvt_pk_bf16_f32 v132, v196, v197
    v_cvt_pk_bf16_f32 v133, v198, v199
    v_cvt_pk_bf16_f32 v134, v200, v201
    v_cvt_pk_bf16_f32 v135, v202, v203
    s_nop 0
    v_permlane32_swap_b32 v132, v134
    v_permlane32_swap_b32 v133, v135
    buffer_store_dwordx4 v[132:135], v27, s[28:31], s51 offen sc1
    v_readfirstlane_b32 s99, v30
    s_setprio 0
    v_lshrrev_b32 v20, 3, v1
    v_and_b32 v21, 2, v20
    v_xor_b32 v21, v21, v1
    v_and_b32 v21, 7, v21
    s_lshl_b32 s87, s101, 7
    s_sub_u32 s42, 1835008, s87
    s_add_u32 s40, s12, s87
    s_addc_u32 s41, s13, 0
    s_add_u32 s92, s14, s87
    s_addc_u32 s93, s15, 0
    s_mov_b32 s24, 28672
    s_cmp_lt_u32 s101, 28
    s_cselect_b32 s42, s42, 0
    s_mov_b32 s94, s42
    s_mov_b32 s43, 0x20000
    s_mov_b32 s95, 0x20000
    s_lshr_b32 s87, s24, 3
    v_mul_u32_u24 v20, s87, v20
    v_lshl_add_u32 v20, v21, 4, v20
    v_xor_b32 v21, 64, v20
    s_lshl_b32 s86, s26, 10
    s_and_b32 s46, s26, 1
    s_lshr_b32 s47, s26, 1
    v_and_b32 v3, 15, v1
    v_lshrrev_b32 v4, 4, v1
    v_bfe_u32 v8, v1, 2, 3
    v_lshrrev_b32 v9, 5, v1
    v_lshl_add_u32 v9, v9, 4, v8
    v_lshlrev_b32 v7, 7, v9
    v_lshrrev_b32 v8, 1, v8
    v_xor_b32 v8, s47, v8
    v_lshl_add_u32 v7, v8, 5, v7
    v_and_b32 v8, 3, v1
    v_lshl_add_u32 v7, v8, 3, v7
    v_add_u32 v9, 131072, v7
    s_mov_b32 s32, s4
    s_mov_b32 s33, s5
    s_mov_b32 s34, 2097152
    s_mov_b32 s35, 0x20000
    v_lshlrev_b32 v5, 11, v3
    v_lshl_add_u32 v5, v4, 3, v5
    s_lshl_b32 s48, s44, 1
    s_add_u32 s48, s48, s46
    s_lshl_b32 s49, s45, 2
    s_add_u32 s49, s49, s47
    s_lshl_b32 s50, s48, 15
    s_lshl_b32 s51, s49, 5
    s_add_u32 s50, s50, s51
    buffer_load_dwordx2 v[200:201], v5, s[32:35], s50 offen
    buffer_load_dwordx2 v[202:203], v5, s[32:35], s50 offen offset:1024
    s_lshl_b32 s51, s47, 5
    s_add_u32 s50, s51, 157696
    v_lshl_add_u32 v6, v4, 3, s50
    s_lshl_b32 s53, s47, 14
    s_lshl_b32 s54, s46, 11
    s_add_u32 s53, s53, s54
    s_lshl_b32 s52, s44, 16
    s_add_u32 s52, s52, s53
    s_mul_i32 s54, s100, 655360
    s_add_u32 s52, s52, s54
    s_add_u32 s52, s52, 9437184
    s_and_b32 s54, s100, 1
    s_lshl_b32 s54, s54, 13
    s_add_u32 s52, s52, s54
    s_add_u32 s53, s53, 0
    s_lshl_b32 s54, s46, 15
    s_add_u32 s54, s54, 0
    v_add_u32 v8, s54, v2
    v_bfe_u32 v10, v1, 4, 1
    v_lshlrev_b32 v10, 9, v10
    v_lshrrev_b32 v11, 5, v1
    v_lshl_add_u32 v11, v11, 4, v3
    v_lshlrev_b32 v11, 4, v11
    v_add_u32 v10, v10, v11
    s_lshl_b32 s56, s48, 5
    s_add_u32 s56, s56, s49
    s_lshl_b32 s56, s56, 10
    s_mul_i32 s55, s100, 16384
    s_add_u32 s56, s56, s55
    s_add_u32 s56, s56, 16777216
    s_lshl_b32 s57, s48, 13
    s_bfe_u32 s58, s49, 0x30001
    s_lshl_b32 s58, s58, 10
    s_add_u32 s57, s57, s58
    s_lshr_b32 s58, s49, 4
    s_lshl_b32 s58, s58, 9
    s_add_u32 s57, s57, s58
    s_and_b32 s58, s49, 1
    s_lshl_b32 s58, s58, 3
    s_add_u32 s57, s57, s58
    s_lshl_b32 s58, s100, 16
    s_add_u32 s57, s57, s58
    s_add_u32 s57, s57, 65536
    ds_read_b64_tr_b16 v[64:65], v7 offset:0
    ds_read_b64_tr_b16 v[66:67], v7 offset:1024
    ds_read_b64_tr_b16 v[68:69], v7 offset:4096
    ds_read_b64_tr_b16 v[70:71], v7 offset:5120
    ds_read_b64_tr_b16 v[72:73], v7 offset:8192
    ds_read_b64_tr_b16 v[74:75], v7 offset:9216
    ds_read_b64_tr_b16 v[76:77], v7 offset:12288
    ds_read_b64_tr_b16 v[78:79], v7 offset:13312
    ds_read_b64_tr_b16 v[80:81], v7 offset:16384
    ds_read_b64_tr_b16 v[82:83], v7 offset:17408
    ds_read_b64_tr_b16 v[84:85], v7 offset:20480
    ds_read_b64_tr_b16 v[86:87], v7 offset:21504
    ds_read_b64_tr_b16 v[88:89], v7 offset:24576
    ds_read_b64_tr_b16 v[90:91], v7 offset:25600
    ds_read_b64_tr_b16 v[92:93], v7 offset:28672
    ds_read_b64_tr_b16 v[94:95], v7 offset:29696
    ds_read_b64_tr_b16 v[96:97], v7 offset:32768
    ds_read_b64_tr_b16 v[98:99], v7 offset:33792
    ds_read_b64_tr_b16 v[100:101], v7 offset:36864
    ds_read_b64_tr_b16 v[102:103], v7 offset:37888
    ds_read_b64_tr_b16 v[104:105], v7 offset:40960
    ds_read_b64_tr_b16 v[106:107], v7 offset:41984
    ds_read_b64_tr_b16 v[108:109], v7 offset:45056
    ds_read_b64_tr_b16 v[110:111], v7 offset:46080
    ds_read_b64_tr_b16 v[112:113], v7 offset:49152
    ds_read_b64_tr_b16 v[114:115], v7 offset:50176
    ds_read_b64_tr_b16 v[116:117], v7 offset:53248
    ds_read_b64_tr_b16 v[118:119], v7 offset:54272
    ds_read_b64_tr_b16 v[120:121], v9 offset:0
    ds_read_b64_tr_b16 v[122:123], v9 offset:1024
    ds_read_b64_tr_b16 v[124:125], v9 offset:4096
    ds_read_b64_tr_b16 v[126:127], v9 offset:5120
    ds_read_b64 v[216:217], v6
    ds_read_b64 v[218:219], v6 offset:256
    s_waitcnt vmcnt(2)
    s_waitcnt lgkmcnt(0)
    s_barrier
    s_branch L_qjoin
L_H:
    s_lshl_b32 s10, s100, 4
    s_and_b32 s10, s10, 48
    s_xor_b32 s10, s10, s101
    s_xor_b32 s10, s10, 32
    s_mul_i32 s10, s10, 24576
    s_add_u32 s10, s10, 6144
    s_add_u32 s10, s6, s10
    s_addc_u32 s11, s7, 0
    s_mul_i32 s87, s27, 12
    s_lshl_b64 exec, 0xfff, s87
    global_load_dword v15, v14, s[10:11]
    s_mov_b64 exec, -1
    s_lshl_b32 s10, s100, 4
    s_and_b32 s10, s10, 48
    s_xor_b32 s10, s10, s101
    s_mul_i32 s10, s10, 24576
    s_add_u32 s10, s10, 12288
    s_add_u32 s10, s6, s10
    s_addc_u32 s11, s7, 0
    s_mul_i32 s87, s27, 12
    s_lshl_b64 exec, 0xfff, s87
    global_load_dword v15, v14, s[10:11]
    s_mov_b64 exec, -1
    s_mov_b32 m0, s50
    s_waitcnt lgkmcnt(3)
    v_lshlrev_b32 v216, 16, v200
    v_and_b32 v217, 0xffff0000, v200
    v_lshlrev_b32 v218, 16, v204
    v_and_b32 v219, 0xffff0000, v204
    s_waitcnt lgkmcnt(1)
    v_lshlrev_b32 v220, 16, v208
    v_and_b32 v221, 0xffff0000, v208
    v_lshlrev_b32 v222, 16, v212
    v_and_b32 v223, 0xffff0000, v212
    v_pk_fma_f32 v[72:73], v[72:73], v[218:219], v[216:217]
    v_pk_fma_f32 v[80:81], v[80:81], v[222:223], v[220:221]
    v_pk_fma_f32 v[88:89], v[88:89], v[218:219], v[216:217]
    v_pk_fma_f32 v[96:97], v[96:97], v[222:223], v[220:221]
    v_pk_fma_f32 v[104:105], v[104:105], v[218:219], v[216:217]
    v_pk_fma_f32 v[112:113], v[112:113], v[222:223], v[220:221]
    v_pk_fma_f32 v[120:121], v[120:121], v[218:219], v[216:217]
    v_pk_fma_f32 v[128:129], v[128:129], v[222:223], v[220:221]
    v_pk_fma_f32 v[136:137], v[136:137], v[218:219], v[216:217]
    v_pk_fma_f32 v[144:145], v[144:145], v[222:223], v[220:221]
    v_cvt_pk_bf16_f32 v72, v72, v73
    v_cvt_pk_bf16_f32 v80, v80, v81
    ds_write_addtid_b32 v72 offset:0
    v_cvt_pk_bf16_f32 v88, v88, v89
    ds_write_addtid_b32 v80 offset:1024
    v_cvt_pk_bf16_f32 v96, v96, v97
    ds_write_addtid_b32 v88 offset:4096
    v_cvt_pk_bf16_f32 v104, v104, v105
    ds_write_addtid_b32 v96 offset:5120
    v_cvt_pk_bf16_f32 v112, v112, v113
    ds_write_addtid_b32 v104 offset:8192
    v_cvt_pk_bf16_f32 v120, v120, v121
    ds_write_addtid_b32 v112 offset:9216
    v_cvt_pk_bf16_f32 v128, v128, v129
    ds_write_addtid_b32 v120 offset:12288
    v_cvt_pk_bf16_f32 v136, v136, v137
    ds_write_addtid_b32 v128 offset:13312
    v_cvt_pk_bf16_f32 v144, v144, v145
    ds_write_addtid_b32 v136 offset:16384
    ds_write_addtid_b32 v144 offset:17408
    s_waitcnt lgkmcnt(10)
    v_readfirstlane_b32 s99, v30
    v_lshrrev_b32 v4, 3, v1
    v_and_b32 v5, 7, v1
    v_mul_u32_u24 v12, 12288, v4
    v_lshl_add_u32 v12, v5, 4, v12
    s_lshl_b32 s52, s100, 2
    s_add_u32 s52, s52, s27
    s_lshl_b32 s53, s52, 5
    v_lshl_add_u32 v4, v4, 2, s53
    s_mul_i32 s52, s52, 98304
    s_lshl_b32 s53, s101, 7
    s_add_u32 s52, s52, s53
    s_add_u32 s53, s52, 6144
    global_load_dword v184, v4, s[18:19]
    buffer_load_dwordx4 v[176:179], v12, s[40:43], s52 offen offset:2048
    buffer_load_dwordx4 v[180:183], v12, s[40:43], s53 offen offset:2048
    s_lshl_b32 s10, s100, 4
    s_and_b32 s10, s10, 48
    s_xor_b32 s10, s10, s101
    s_xor_b32 s10, s10, 32
    s_mul_i32 s10, s10, 24576
    s_add_u32 s10, s10, 12288
    s_add_u32 s10, s6, s10
    s_addc_u32 s11, s7, 0
    s_mul_i32 s87, s27, 12
    s_lshl_b64 exec, 0xfff, s87
    global_load_dword v15, v14, s[10:11]
    s_mov_b64 exec, -1
    s_lshl_b32 s10, s100, 4
    s_and_b32 s10, s10, 48
    s_xor_b32 s10, s10, s101
    s_mul_i32 s10, s10, 24576
    s_add_u32 s10, s10, 18432
    s_add_u32 s10, s6, s10
    s_addc_u32 s11, s7, 0
    s_mul_i32 s87, s27, 12
    s_lshl_b64 exec, 0xfff, s87
    global_load_dword v15, v14, s[10:11]
    s_mov_b64 exec, -1
    s_mov_b32 m0, s50
    v_lshlrev_b32 v216, 16, v201
    v_and_b32 v217, 0xffff0000, v201
    v_lshlrev_b32 v218, 16, v205
    v_and_b32 v219, 0xffff0000, v205
    v_lshlrev_b32 v220, 16, v209
    v_and_b32 v221, 0xffff0000, v209
    v_lshlrev_b32 v222, 16, v213
    v_and_b32 v223, 0xffff0000, v213
    v_pk_fma_f32 v[74:75], v[74:75], v[218:219], v[216:217]
    v_pk_fma_f32 v[82:83], v[82:83], v[222:223], v[220:221]
    v_pk_fma_f32 v[90:91], v[90:91], v[218:219], v[216:217]
    v_pk_fma_f32 v[98:99], v[98:99], v[222:223], v[220:221]
    v_pk_fma_f32 v[106:107], v[106:107], v[218:219], v[216:217]
    v_pk_fma_f32 v[114:115], v[114:115], v[222:223], v[220:221]
    v_pk_fma_f32 v[122:123], v[122:123], v[218:219], v[216:217]
    v_pk_fma_f32 v[130:131], v[130:131], v[222:223], v[220:221]
    v_pk_fma_f32 v[138:139], v[138:139], v[218:219], v[216:217]
    v_pk_fma_f32 v[146:147], v[146:147], v[222:223], v[220:221]
    v_cvt_pk_bf16_f32 v74, v74, v75
    v_cvt_pk_bf16_f32 v82, v82, v83
    ds_write_addtid_b32 v74 offset:20480
    v_cvt_pk_bf16_f32 v90, v90, v91
    ds_write_addtid_b32 v82 offset:21504
    v_cvt_pk_bf16_f32 v98, v98, v99
    ds_write_addtid_b32 v90 offset:24576
    v_cvt_pk_bf16_f32 v106, v106, v107
    ds_write_addtid_b32 v98 offset:25600
    v_cvt_pk_bf16_f32 v114, v114, v115
    ds_write_addtid_b32 v106 offset:28672
    v_cvt_pk_bf16_f32 v122, v122, v123
    ds_write_addtid_b32 v114 offset:29696
    v_cvt_pk_bf16_f32 v130, v130, v131
    ds_write_addtid_b32 v122 offset:32768
    v_cvt_pk_bf16_f32 v138, v138, v139
    ds_write_addtid_b32 v130 offset:33792
    v_cvt_pk_bf16_f32 v146, v146, v147
    ds_write_addtid_b32 v138 offset:36864
    ds_write_addtid_b32 v146 offset:37888
    s_xor_b32 s98, s98, s99
    s_waitcnt lgkmcnt(0)
    s_barrier
    s_setprio 2
    s_lshl_b32 s10, s100, 4
    s_and_b32 s10, s10, 48
    s_xor_b32 s10, s10, s101
    s_xor_b32 s10, s10, 32
    s_mul_i32 s10, s10, 24576
    s_add_u32 s10, s10, 18432
    s_add_u32 s10, s6, s10
    s_addc_u32 s11, s7, 0
    s_mul_i32 s87, s27, 12
    s_lshl_b64 exec, 0xfff, s87
    global_load_dword v15, v14, s[10:11]
    s_mov_b64 exec, -1
    v_lshrrev_b32 v10, 3, v1
    v_and_b32 v8, 7, v1
    v_and_b32 v9, 6, v10
    v_xor_b32 v8, v8, v9
    v_lshlrev_b32 v10, 10, v10
    v_lshl_add_u32 v10, v8, 4, v10
    s_mov_b32 s36, s8
    s_mov_b32 s37, s9
    s_mov_b32 s38, 524288
    s_mov_b32 s39, 0x20000
    s_lshl_b32 s56, s27, 13
    s_lshl_b32 s57, s45, 7
    s_add_u32 s56, s56, s57
    s_lshl_b32 s57, s27, 10
    s_and_b32 s55, s100, 1
    s_lshl_b32 s55, s55, 18
    v_lshrrev_b32 v20, 3, v1
    v_and_b32 v21, 2, v20
    v_xor_b32 v21, v21, v1
    v_and_b32 v21, 7, v21
    s_lshl_b32 s87, s101, 7
    s_sub_u32 s42, 1835008, s87
    s_add_u32 s40, s12, s87
    s_addc_u32 s41, s13, 0
    s_add_u32 s92, s14, s87
    s_addc_u32 s93, s15, 0
    s_mov_b32 s24, 28672
    s_cmp_lt_u32 s101, 28
    s_cselect_b32 s42, s42, 0
    s_mov_b32 s94, s42
    s_mov_b32 s43, 0x20000
    s_mov_b32 s95, 0x20000
    s_lshr_b32 s87, s24, 3
    v_mul_u32_u24 v20, s87, v20
    v_lshl_add_u32 v20, v21, 4, v20
    v_xor_b32 v21, 64, v20
    s_lshl_b32 s86, s26, 10
    s_add_u32 m0, s50, 40960
    v_lshlrev_b32 v216, 16, v202
    v_and_b32 v217, 0xffff0000, v202
    v_lshlrev_b32 v218, 16, v206
    v_and_b32 v219, 0xffff0000, v206
    v_lshlrev_b32 v220, 16, v210
    v_and_b32 v221, 0xffff0000, v210
    v_lshlrev_b32 v222, 16, v214
    v_and_b32 v223, 0xffff0000, v214
    v_fma_f32 v76, v76, v218, v216
    v_fma_f32 v77, v77, v219, v217
    v_fma_f32 v84, v84, v222, v220
    v_fma_f32 v85, v85, v223, v221
    v_fma_f32 v92, v92, v218, v216
    v_fma_f32 v93, v93, v219, v217
    v_fma_f32 v100, v100, v222, v220
    v_fma_f32 v101, v101, v223, v221
    v_fma_f32 v108, v108, v218, v216
    v_fma_f32 v109, v109, v219, v217
    v_fma_f32 v116, v116, v222, v220
    v_fma_f32 v117, v117, v223, v221
    v_fma_f32 v124, v124, v218, v216
    v_fma_f32 v125, v125, v219, v217
    v_fma_f32 v132, v132, v222, v220
    v_fma_f32 v133, v133, v223, v221
    v_fma_f32 v140, v140, v218, v216
    v_fma_f32 v141, v141, v219, v217
    v_fma_f32 v148, v148, v222, v220
    v_fma_f32 v149, v149, v223, v221
    v_cvt_pk_bf16_f32 v76, v76, v77
    v_cvt_pk_bf16_f32 v84, v84, v85
    ds_write_addtid_b32 v76 offset:0
    v_cvt_pk_bf16_f32 v92, v92, v93
    ds_write_addtid_b32 v84 offset:1024
    v_cvt_pk_bf16_f32 v100, v100, v101
    ds_write_addtid_b32 v92 offset:4096
    v_cvt_pk_bf16_f32 v108, v108, v109
    ds_write_addtid_b32 v100 offset:5120
    v_cvt_pk_bf16_f32 v116, v116, v117
    ds_write_addtid_b32 v108 offset:8192
    v_cvt_pk_bf16_f32 v124, v124, v125
    ds_write_addtid_b32 v116 offset:9216
    v_cvt_pk_bf16_f32 v132, v132, v133
    ds_write_addtid_b32 v124 offset:12288
    v_cvt_pk_bf16_f32 v140, v140, v141
    ds_write_addtid_b32 v132 offset:13312
    v_cvt_pk_bf16_f32 v148, v148, v149
    ds_write_addtid_b32 v140 offset:16384
    ds_write_addtid_b32 v148 offset:17408
    s_waitcnt lgkmcnt(0)
    s_barrier
    s_xor_b32 s58, s46, 2
    s_mul_i32 s58, s58, 393216
    s_add_u32 s58, s58, s47
    s_add_u32 s58, s58, 6144
    s_add_u32 m0, s48, 81920
    s_nop 0
    buffer_load_dwordx4 v3, s[32:35], s58 offen offset:0 lds
    s_add_u32 m0, s48, 81920
    s_nop 0
    buffer_load_dwordx4 v3, s[32:35], s58 offen offset:1024 lds
    s_add_u32 s10, s100, 0
    s_and_b32 s10, s10, 1
    s_lshl_b32 s10, s10, 5
    s_add_u32 s10, s10, s101
    s_lshl_b32 s10, s10, 13
    s_add_u32 s10, s8, s10
    s_addc_u32 s11, s9, 0
    s_mul_i32 s87, s27, 16
    s_lshl_b64 exec, 0xffff, s87
    global_load_dword v15, v14, s[10:11]
    s_mov_b64 exec, -1
    s_waitcnt vmcnt(6)
    v_lshlrev_b32 v186, 16, v184
    v_and_b32 v187, 0xffff0000, v184
    s_mov_b32 s52, 0xbfb8aa3b
    v_mul_f32 v152, s52, v186
    v_mul_f32 v153, s52, v187
    v_exp_f32 v152, v152
    v_exp_f32 v153, v153
    v_add_f32 v152, 1.0, v152
    v_add_f32 v153, 1.0, v153
    s_add_u32 m0, s48, 81920
    s_nop 0
    buffer_load_dwordx4 v3, s[32:35], s58 offen offset:2048 lds
    v_rcp_f32 v152, v152
    v_rcp_f32 v153, v153
    v_mul_f32 v186, v186, v152
    v_mul_f32 v187, v187, v153
    v_cvt_pk_bf16_f32 v152, v186, v187
    v_lshlrev_b32 v186, 16, v152
    v_and_b32 v187, 0xffff0000, v152
    v_lshlrev_b32 v152, 16, v176
    s_xor_b32 s58, s46, 3
    s_mul_i32 s58, s58, 393216
    s_add_u32 s58, s58, s47
    s_add_u32 s58, s58, 6144
    s_add_u32 m0, s48, 94208
    s_nop 0
    buffer_load_dwordx4 v3, s[32:35], s58 offen offset:0 lds
    v_and_b32 v153, 0xffff0000, v176
    v_lshlrev_b32 v154, 16, v177
    v_and_b32 v155, 0xffff0000, v177
    v_lshlrev_b32 v156, 16, v178
    v_and_b32 v157, 0xffff0000, v178
    v_lshlrev_b32 v158, 16, v179
    v_and_b32 v159, 0xffff0000, v179
    v_pk_mul_f32 v[188:189], v[152:153], v[186:187] op_sel:[0,0] op_sel_hi:[1,0]
    s_add_u32 m0, s48, 94208
    s_nop 0
    buffer_load_dwordx4 v3, s[32:35], s58 offen offset:1024 lds
    v_pk_mul_f32 v[190:191], v[154:155], v[186:187] op_sel:[0,0] op_sel_hi:[1,0]
    v_pk_mul_f32 v[192:193], v[156:157], v[186:187] op_sel:[0,0] op_sel_hi:[1,0]
    v_pk_mul_f32 v[194:195], v[158:159], v[186:187] op_sel:[0,0] op_sel_hi:[1,0]
    v_lshlrev_b32 v152, 16, v180
    v_and_b32 v153, 0xffff0000, v180
    v_lshlrev_b32 v154, 16, v181
    v_and_b32 v155, 0xffff0000, v181
    v_lshlrev_b32 v156, 16, v182
    s_add_u32 m0, s48, 94208
    s_nop 0
    buffer_load_dwordx4 v3, s[32:35], s58 offen offset:2048 lds
    v_and_b32 v157, 0xffff0000, v182
    v_lshlrev_b32 v158, 16, v183
    v_and_b32 v159, 0xffff0000, v183
    v_pk_fma_f32 v[188:189], v[152:153], v[186:187], v[188:189] op_sel:[0,1,0] op_sel_hi:[1,1,1]
    v_pk_fma_f32 v[190:191], v[154:155], v[186:187], v[190:191] op_sel:[0,1,0] op_sel_hi:[1,1,1]
    v_pk_fma_f32 v[192:193], v[156:157], v[186:187], v[192:193] op_sel:[0,1,0] op_sel_hi:[1,1,1]
    v_pk_fma_f32 v[194:195], v[158:159], v[186:187], v[194:195] op_sel:[0,1,0] op_sel_hi:[1,1,1]
    v_and_b32 v5, 7, v1
    v_lshrrev_b32 v9, 4, v1
    v_lshl_add_u32 v9, v5, 2, v9
    s_lshl_b32 s53, s27, 8
    s_add_u32 s53, s53, 155648
    v_lshl_add_u32 v9, v9, 3, s53
    v_permlane32_swap_b32 v188, v192
    v_permlane32_swap_b32 v189, v193
    v_permlane32_swap_b32 v190, v194
    v_permlane32_swap_b32 v191, v195
    v_add_f32 v188, v188, v192
    v_add_f32 v189, v189, v193
    v_add_f32 v190, v190, v194
    v_add_f32 v191, v191, v195
    s_nop 0
    v_permlane16_swap_b32 v188, v190
    v_permlane16_swap_b32 v189, v191
    v_add_f32 v188, v188, v190
    v_add_f32 v189, v189, v191
    s_nop 0
    v_add_f32_dpp v188, v188, v188 row_ror:8 row_mask:0xf bank_mask:0xf
    v_add_f32_dpp v189, v189, v189 row_ror:8 row_mask:0xf bank_mask:0xf
    ds_write_b64 v9, v[188:189] offset:0
    s_waitcnt lgkmcnt(0)
    s_barrier
    v_lshlrev_b32 v4, 3, v1
    v_add_u32 v4, 155648, v4
    ds_read_b64 v[176:177], v4 offset:0
    ds_read_b64 v[178:179], v4 offset:256
    ds_read_b64 v[180:181], v4 offset:512
    ds_read_b64 v[182:183], v4 offset:768
    s_lshl_b32 s53, s101, 3
    s_add_u32 s53, s53, s100
    s_lshl_b32 s53, s53, 9
    s_add_u32 s53, s53, 1638400
    s_lshl_b32 s52, s27, 3
    s_xor_b32 s58, s46, 0
    s_mul_i32 s58, s58, 393216
    s_add_u32 s58, s58, s47
    s_add_u32 s58, s58, 12288
    s_add_u32 m0, s48, 106496
    s_nop 0
    buffer_load_dwordx4 v3, s[32:35], s58 offen offset:0 lds
    s_add_u32 m0, s48, 106496
    s_nop 0
    buffer_load_dwordx4 v3, s[32:35], s58 offen offset:1024 lds
    s_waitcnt lgkmcnt(0)
    v_pk_add_f32 v[176:177], v[176:177], v[180:181]
    v_pk_add_f32 v[178:179], v[178:179], v[182:183]
    v_pk_add_f32 v[176:177], v[176:177], v[178:179]
    v_mov_b32 v178, s99
    v_mov_b32 v179, s99
    s_lshl_b64 exec, 0xff, s52
    buffer_store_dwordx4 v[176:179], v2, s[28:31], s53 offen sc1
    s_mov_b64 exec, -1
    s_add_u32 s10, s100, 1
    s_and_b32 s10, s10, 1
    s_lshl_b32 s10, s10, 5
    s_add_u32 s10, s10, s101
    s_lshl_b32 s10, s10, 13
    s_add_u32 s10, s8, s10
    s_addc_u32 s11, s9, 0
    s_mul_i32 s87, s27, 16
    s_lshl_b64 exec, 0xffff, s87
    global_load_dword v15, v14, s[10:11]
    s_mov_b64 exec, -1
    s_add_u32 m0, s50, 40960
    v_lshlrev_b32 v216, 16, v203
    v_and_b32 v217, 0xffff0000, v203
    v_lshlrev_b32 v218, 16, v207
    v_and_b32 v219, 0xffff0000, v207
    v_lshlrev_b32 v220, 16, v211
    v_and_b32 v221, 0xffff0000, v211
    s_add_u32 m0, s48, 106496
    s_nop 0
    buffer_load_dwordx4 v3, s[32:35], s58 offen offset:2048 lds
    s_add_u32 m0, s50, 40960
    v_lshlrev_b32 v222, 16, v215
    v_and_b32 v223, 0xffff0000, v215
    v_fma_f32 v78, v78, v218, v216
    v_fma_f32 v79, v79, v219, v217
    v_fma_f32 v86, v86, v222, v220
    v_fma_f32 v87, v87, v223, v221
    s_xor_b32 s58, s46, 1
    s_mul_i32 s58, s58, 393216
    s_add_u32 s58, s58, s47
    s_add_u32 s58, s58, 12288
    s_add_u32 m0, s48, 118784
    s_nop 0
    buffer_load_dwordx4 v3, s[32:35], s58 offen offset:0 lds
    s_add_u32 m0, s50, 40960
    v_fma_f32 v94, v94, v218, v216
    v_fma_f32 v95, v95, v219, v217
    v_fma_f32 v102, v102, v222, v220
    v_fma_f32 v103, v103, v223, v221
    v_fma_f32 v110, v110, v218, v216
    v_fma_f32 v111, v111, v219, v217
    s_add_u32 m0, s48, 118784
    s_nop 0
    buffer_load_dwordx4 v3, s[32:35], s58 offen offset:1024 lds
    s_add_u32 m0, s50, 40960
    v_fma_f32 v118, v118, v222, v220
    v_fma_f32 v119, v119, v223, v221
    v_fma_f32 v126, v126, v218, v216
    v_fma_f32 v127, v127, v219, v217
    v_fma_f32 v134, v134, v222, v220
    v_fma_f32 v135, v135, v223, v221
    s_add_u32 m0, s48, 118784
    s_nop 0
    buffer_load_dwordx4 v3, s[32:35], s58 offen offset:2048 lds
    s_add_u32 m0, s50, 40960
    v_fma_f32 v142, v142, v218, v216
    v_fma_f32 v143, v143, v219, v217
    v_fma_f32 v150, v150, v222, v220
    v_fma_f32 v151, v151, v223, v221
    v_cvt_pk_bf16_f32 v78, v78, v79
    v_cvt_pk_bf16_f32 v86, v86, v87
    ds_write_addtid_b32 v78 offset:20480
    v_cvt_pk_bf16_f32 v94, v94, v95
    ds_write_addtid_b32 v86 offset:21504
    v_cvt_pk_bf16_f32 v102, v102, v103
    ds_write_addtid_b32 v94 offset:24576
    v_cvt_pk_bf16_f32 v110, v110, v111
    ds_write_addtid_b32 v102 offset:25600
    v_cvt_pk_bf16_f32 v118, v118, v119
    ds_write_addtid_b32 v110 offset:28672
    v_cvt_pk_bf16_f32 v126, v126, v127
    ds_write_addtid_b32 v118 offset:29696
    v_cvt_pk_bf16_f32 v134, v134, v135
    ds_write_addtid_b32 v126 offset:32768
    v_cvt_pk_bf16_f32 v142, v142, v143
    ds_write_addtid_b32 v134 offset:33792
    v_cvt_pk_bf16_f32 v150, v150, v151
    ds_write_addtid_b32 v142 offset:36864
    ds_write_addtid_b32 v150 offset:37888
    s_waitcnt vmcnt(8) lgkmcnt(0)
    s_barrier
    s_xor_b32 s53, s46, 2
    s_mul_i32 s53, s53, 393216
    s_add_u32 m0, s48, 131072
    s_add_u32 s53, s53, s47
    s_add_u32 s53, s53, 12288
    buffer_load_dwordx4 v3, s[32:35], s53 offen offset:0 lds
    buffer_load_dwordx4 v3, s[32:35], s53 offen offset:1024 lds
    buffer_load_dwordx4 v3, s[32:35], s53 offen offset:2048 lds
    s_xor_b32 s53, s46, 3
    s_mul_i32 s53, s53, 393216
    s_add_u32 m0, s48, 143360
    s_add_u32 s53, s53, s47
    s_add_u32 s53, s53, 12288
    buffer_load_dwordx4 v3, s[32:35], s53 offen offset:0 lds
    buffer_load_dwordx4 v3, s[32:35], s53 offen offset:1024 lds
    buffer_load_dwordx4 v3, s[32:35], s53 offen offset:2048 lds
    s_add_u32 m0, s57, 0
    s_xor_b32 s52, s55, 0
    s_add_u32 s52, s52, s56
    buffer_load_dwordx4 v10, s[36:39], s52 offen lds
    s_add_u32 m0, s57, 4096
    s_xor_b32 s52, s55, 32768
    s_add_u32 s52, s52, s56
    buffer_load_dwordx4 v10, s[36:39], s52 offen lds
    s_waitcnt vmcnt(8)
    s_barrier
    s_xor_b32 s53, s46, 0
    s_mul_i32 s53, s53, 393216
    s_add_u32 m0, s48, 81920
    s_add_u32 s53, s53, s47
    s_add_u32 s53, s53, 18432
    buffer_load_dwordx4 v3, s[32:35], s53 offen offset:0 lds
    buffer_load_dwordx4 v3, s[32:35], s53 offen offset:1024 lds
    buffer_load_dwordx4 v3, s[32:35], s53 offen offset:2048 lds
    s_xor_b32 s53, s46, 1
    s_mul_i32 s53, s53, 393216
    s_add_u32 m0, s48, 94208
    s_add_u32 s53, s53, s47
    s_add_u32 s53, s53, 18432
    buffer_load_dwordx4 v3, s[32:35], s53 offen offset:0 lds
    buffer_load_dwordx4 v3, s[32:35], s53 offen offset:1024 lds
    buffer_load_dwordx4 v3, s[32:35], s53 offen offset:2048 lds
    s_add_u32 m0, s57, 8192
    s_xor_b32 s52, s55, 65536
    s_add_u32 s52, s52, s56
    buffer_load_dwordx4 v10, s[36:39], s52 offen lds
    s_add_u32 m0, s57, 12288
    s_xor_b32 s52, s55, 98304
    s_add_u32 s52, s52, s56
    buffer_load_dwordx4 v10, s[36:39], s52 offen lds
    s_waitcnt vmcnt(10)
    s_barrier
    s_xor_b32 s53, s46, 2
    s_mul_i32 s53, s53, 393216
    s_add_u32 m0, s48, 106496
    s_add_u32 s53, s53, s47
    s_add_u32 s53, s53, 18432
    buffer_load_dwordx4 v3, s[32:35], s53 offen offset:0 lds
    buffer_load_dwordx4 v3, s[32:35], s53 offen offset:1024 lds
    buffer_load_dwordx4 v3, s[32:35], s53 offen offset:2048 lds
    s_xor_b32 s53, s46, 3
    s_mul_i32 s53, s53, 393216
    s_add_u32 m0, s48, 118784
    s_add_u32 s53, s53, s47
    s_add_u32 s53, s53, 18432
    buffer_load_dwordx4 v3, s[32:35], s53 offen offset:0 lds
    buffer_load_dwordx4 v3, s[32:35], s53 offen offset:1024 lds
    buffer_load_dwordx4 v3, s[32:35], s53 offen offset:2048 lds
    s_lshl_b32 s54, s27, 3
    s_add_u32 s54, s54, s45
    s_lshl_b32 s54, s54, 12
    s_add_u32 s54, s54, 1638400
    buffer_load_dwordx4 v[32:35], v2, s[28:31], s54 offen offset:0 sc1
    buffer_load_dwordx4 v[36:39], v2, s[28:31], s54 offen offset:1024 sc1
    buffer_load_dwordx4 v[40:43], v2, s[28:31], s54 offen offset:2048 sc1
    buffer_load_dwordx4 v[44:47], v2, s[28:31], s54 offen offset:3072 sc1
    s_add_u32 m0, s57, 16384
    s_xor_b32 s52, s55, 131072
    s_add_u32 s52, s52, s56
    buffer_load_dwordx4 v10, s[36:39], s52 offen lds
    s_waitcnt vmcnt(13)
    s_barrier
    buffer_load_dword v19, v13, s[28:31], s96 offen offset:512 sc1
    s_add_u32 m0, s57, 20480
    s_xor_b32 s52, s55, 163840
    s_add_u32 s52, s52, s56
    buffer_load_dwordx4 v10, s[36:39], s52 offen lds
    s_add_u32 m0, s57, 24576
    s_xor_b32 s52, s55, 196608
    s_add_u32 s52, s52, s56
    buffer_load_dwordx4 v10, s[36:39], s52 offen lds
    s_add_u32 m0, s57, 28672
    s_xor_b32 s52, s55, 229376
    s_add_u32 s52, s52, s56
    buffer_load_dwordx4 v10, s[36:39], s52 offen lds
    s_add_u32 s58, s100, 0
    s_and_b32 s58, s58, 7
    s_lshl3_add_u32 s58, s58, s26
    s_mul_i32 s87, s58, s24
    s_add_u32 m0, s86, 139264
    s_nop 0
    buffer_load_dwordx4 v20, s[40:43], s87 offen lds
    s_add_u32 m0, s86, 147456
    s_nop 0
    buffer_load_dwordx4 v21, s[92:95], s87 offen lds
    s_sub_u32 s58, s58, 4
    s_mul_i32 s87, s58, s24
    s_add_u32 m0, s86, 135168
    s_nop 0
    buffer_load_dwordx4 v20, s[40:43], s87 offen lds
    s_add_u32 m0, s86, 143360
    s_nop 0
    buffer_load_dwordx4 v21, s[92:95], s87 offen lds
    s_waitcnt vmcnt(13)
    s_barrier
    s_add_u32 m0, s57, 32768
    s_xor_b32 s52, s55, 262144
    s_add_u32 s52, s52, s56
    buffer_load_dwordx4 v10, s[36:39], s52 offen lds
    s_add_u32 m0, s57, 36864
    s_xor_b32 s52, s55, 294912
    s_add_u32 s52, s52, s56
    buffer_load_dwordx4 v10, s[36:39], s52 offen lds
    s_add_u32 m0, s57, 40960
    s_xor_b32 s52, s55, 327680
    s_add_u32 s52, s52, s56
    buffer_load_dwordx4 v10, s[36:39], s52 offen lds
    s_add_u32 m0, s57, 45056
    s_xor_b32 s52, s55, 360448
    s_add_u32 s52, s52, s56
    buffer_load_dwordx4 v10, s[36:39], s52 offen lds
    s_add_u32 m0, s57, 49152
    s_xor_b32 s52, s55, 393216
    s_add_u32 s52, s52, s56
    buffer_load_dwordx4 v10, s[36:39], s52 offen lds
    s_add_u32 m0, s57, 53248
    s_xor_b32 s52, s55, 425984
    s_add_u32 s52, s52, s56
    buffer_load_dwordx4 v10, s[36:39], s52 offen lds
    s_barrier
    s_add_u32 m0, s57, 131072
    s_xor_b32 s52, s55, 458752
    s_add_u32 s52, s52, s56
    buffer_load_dwordx4 v10, s[36:39], s52 offen lds
    s_add_u32 m0, s57, 135168
    s_xor_b32 s52, s55, 491520
    s_add_u32 s52, s52, s56
    buffer_load_dwordx4 v10, s[36:39], s52 offen lds
    s_cmp_eq_u32 s27, 2
    s_cselect_b32 s58, 1.0, 0
    v_bfe_u32 v4, v1, 3, 2
    s_sub_u32 s52, s45, s100
    s_and_b32 s52, s52, 7
    s_lshl_b32 s52, s52, 7
    v_lshl_add_u32 v4, v4, 5, s52
    v_and_b32 v5, 2, v1
    v_lshl_add_u32 v4, v5, 3, v4
    v_and_b32 v5, 4, v1
    v_lshl_add_u32 v4, v5, 1, v4
    v_and_b32 v5, 1, v1
    v_lshl_add_u32 v4, v5, 2, v4
    s_lshl_b32 s52, s27, 7
    s_add_u32 s52, s52, 157696
    v_add_u32 v5, s52, v13
    s_lshl_b32 s60, s27, 1
    s_lshr_b32 s60, 0x87, s60
    s_and_b32 s60, s60, 3
    s_lshl_b32 s60, s60, 10
    s_add_u32 s60, s60, s97
    s_add_u32 s60, s60, 4096
    s_mov_b32 s59, 0
    s_waitcnt vmcnt(17)
    s_branch Lre_31
Lr_29:
    buffer_load_dwordx4 v[32:35], v2, s[28:31], s54 offen offset:0 sc1
    buffer_load_dwordx4 v[36:39], v2, s[28:31], s54 offen offset:1024 sc1
    buffer_load_dwordx4 v[40:43], v2, s[28:31], s54 offen offset:2048 sc1
    buffer_load_dwordx4 v[44:47], v2, s[28:31], s54 offen offset:3072 sc1
    s_add_u32 s59, s59, 1
    s_waitcnt vmcnt(0)
Lre_31:
    v_xor_b32 v34, s99, v34
    v_xor_b32 v38, s99, v38
    v_xor_b32 v42, s99, v42
    v_xor_b32 v46, s99, v46
    v_or3_b32 v34, v34, v38, v42
    v_or_b32 v34, v34, v46
    v_cmp_ne_u32 vcc, 0, v34
    v_pk_add_f32 v[32:33], v[32:33], v[36:37]
    v_pk_add_f32 v[40:41], v[40:41], v[44:45]
    s_cmp_gt_u32 s59, 200000
    s_cbranch_scc1 Lrd_30
    s_cbranch_vccnz Lr_29
Lrd_30:
    v_pk_add_f32 v[32:33], v[32:33], v[40:41]
    v_mov_b32 v34, v32
    v_mov_b32 v35, v33
    s_nop 0
    v_permlane32_swap_b32 v32, v34
    v_permlane32_swap_b32 v33, v35
    v_pk_add_f32 v[32:33], v[32:33], v[34:35]
    v_cvt_pk_bf16_f32 v32, v32, v33
    v_and_b32 v33, 0xffff0000, v32
    v_lshlrev_b32 v32, 16, v32
    v_add_f32 v32, s58, v32
    v_add_f32 v33, s58, v33
    v_cvt_pk_bf16_f32 v32, v32, v33
    s_mov_b32 exec_hi, 0
    ds_write_b32 v5, v32
    buffer_store_dword v32, v4, s[28:31], s60 offen
    s_mov_b32 exec_hi, -1
    s_add_u32 s58, s100, 1
    s_and_b32 s58, s58, 7
    s_lshl3_add_u32 s58, s58, s26
    s_mul_i32 s87, s58, s24
    s_add_u32 m0, s86, 81920
    s_nop 0
    buffer_load_dwordx4 v20, s[40:43], s87 offen lds
    s_add_u32 m0, s86, 90112
    s_nop 0
    buffer_load_dwordx4 v21, s[92:95], s87 offen lds
    s_sub_u32 s58, s58, 4
    s_mul_i32 s87, s58, s24
    s_add_u32 m0, s86, 77824
    s_nop 0
    buffer_load_dwordx4 v20, s[40:43], s87 offen lds
    s_add_u32 m0, s86, 86016
    s_nop 0
    buffer_load_dwordx4 v21, s[92:95], s87 offen lds
    s_setprio 0
    s_and_b32 s46, s26, 1
    s_lshr_b32 s47, s26, 1
    v_and_b32 v3, 15, v1
    v_lshrrev_b32 v4, 4, v1
    v_bfe_u32 v8, v1, 2, 3
    v_lshrrev_b32 v9, 5, v1
    v_lshl_add_u32 v9, v9, 4, v8
    v_lshlrev_b32 v7, 7, v9
    v_lshrrev_b32 v8, 1, v8
    v_xor_b32 v8, s47, v8
    v_lshl_add_u32 v7, v8, 5, v7
    v_and_b32 v8, 3, v1
    v_lshl_add_u32 v7, v8, 3, v7
    v_add_u32 v9, 131072, v7
    s_mov_b32 s32, s4
    s_mov_b32 s33, s5
    s_mov_b32 s34, 2097152
    s_mov_b32 s35, 0x20000
    v_lshlrev_b32 v5, 11, v3
    v_lshl_add_u32 v5, v4, 3, v5
    s_lshl_b32 s48, s44, 1
    s_add_u32 s48, s48, s46
    s_lshl_b32 s49, s45, 2
    s_add_u32 s49, s49, s47
    s_lshl_b32 s50, s48, 15
    s_lshl_b32 s51, s49, 5
    s_add_u32 s50, s50, s51
    buffer_load_dwordx2 v[200:201], v5, s[32:35], s50 offen
    buffer_load_dwordx2 v[202:203], v5, s[32:35], s50 offen offset:1024
    s_lshl_b32 s51, s47, 5
    s_add_u32 s50, s51, 157696
    v_lshl_add_u32 v6, v4, 3, s50
    s_lshl_b32 s53, s47, 14
    s_lshl_b32 s54, s46, 11
    s_add_u32 s53, s53, s54
    s_lshl_b32 s52, s44, 16
    s_add_u32 s52, s52, s53
    s_mul_i32 s54, s100, 655360
    s_add_u32 s52, s52, s54
    s_add_u32 s52, s52, 9437184
    s_and_b32 s54, s100, 1
    s_lshl_b32 s54, s54, 13
    s_add_u32 s52, s52, s54
    s_add_u32 s53, s53, 0
    s_lshl_b32 s54, s46, 15
    s_add_u32 s54, s54, 0
    v_add_u32 v8, s54, v2
    v_bfe_u32 v10, v1, 4, 1
    v_lshlrev_b32 v10, 9, v10
    v_lshrrev_b32 v11, 5, v1
    v_lshl_add_u32 v11, v11, 4, v3
    v_lshlrev_b32 v11, 4, v11
    v_add_u32 v10, v10, v11
    s_lshl_b32 s56, s48, 5
    s_add_u32 s56, s56, s49
    s_lshl_b32 s56, s56, 10
    s_mul_i32 s55, s100, 16384
    s_add_u32 s56, s56, s55
    s_add_u32 s56, s56, 16777216
    s_lshl_b32 s57, s48, 13
    s_bfe_u32 s58, s49, 0x30001
    s_lshl_b32 s58, s58, 10
    s_add_u32 s57, s57, s58
    s_lshr_b32 s58, s49, 4
    s_lshl_b32 s58, s58, 9
    s_add_u32 s57, s57, s58
    s_and_b32 s58, s49, 1
    s_lshl_b32 s58, s58, 3
    s_add_u32 s57, s57, s58
    s_lshl_b32 s58, s100, 16
    s_add_u32 s57, s57, s58
    s_add_u32 s57, s57, 65536
    s_waitcnt vmcnt(7)
    s_waitcnt lgkmcnt(0)
    s_barrier
    ds_read_b64_tr_b16 v[64:65], v7 offset:0
    ds_read_b64_tr_b16 v[66:67], v7 offset:1024
    ds_read_b64_tr_b16 v[68:69], v7 offset:4096
    ds_read_b64_tr_b16 v[70:71], v7 offset:5120
    ds_read_b64_tr_b16 v[72:73], v7 offset:8192
    ds_read_b64_tr_b16 v[74:75], v7 offset:9216
    ds_read_b64_tr_b16 v[76:77], v7 offset:12288
    ds_read_b64_tr_b16 v[78:79], v7 offset:13312
    ds_read_b64_tr_b16 v[80:81], v7 offset:16384
    ds_read_b64_tr_b16 v[82:83], v7 offset:17408
    ds_read_b64_tr_b16 v[84:85], v7 offset:20480
    ds_read_b64_tr_b16 v[86:87], v7 offset:21504
    ds_read_b64_tr_b16 v[88:89], v7 offset:24576
    ds_read_b64_tr_b16 v[90:91], v7 offset:25600
    ds_read_b64_tr_b16 v[92:93], v7 offset:28672
    ds_read_b64_tr_b16 v[94:95], v7 offset:29696
    ds_read_b64_tr_b16 v[96:97], v7 offset:32768
    ds_read_b64_tr_b16 v[98:99], v7 offset:33792
    ds_read_b64_tr_b16 v[100:101], v7 offset:36864
    ds_read_b64_tr_b16 v[102:103], v7 offset:37888
    ds_read_b64_tr_b16 v[104:105], v7 offset:40960
    ds_read_b64_tr_b16 v[106:107], v7 offset:41984
    ds_read_b64_tr_b16 v[108:109], v7 offset:45056
    ds_read_b64_tr_b16 v[110:111], v7 offset:46080
    ds_read_b64_tr_b16 v[112:113], v7 offset:49152
    ds_read_b64_tr_b16 v[114:115], v7 offset:50176
    ds_read_b64_tr_b16 v[116:117], v7 offset:53248
    ds_read_b64_tr_b16 v[118:119], v7 offset:54272
    ds_read_b64_tr_b16 v[120:121], v9 offset:0
    ds_read_b64_tr_b16 v[122:123], v9 offset:1024
    ds_read_b64_tr_b16 v[124:125], v9 offset:4096
    ds_read_b64_tr_b16 v[126:127], v9 offset:5120
    ds_read_b64 v[216:217], v6
    ds_read_b64 v[218:219], v6 offset:256
    s_waitcnt vmcnt(6)
    s_waitcnt lgkmcnt(0)
    s_barrier
    s_cmp_eq_u32 s26, 7
    s_cbranch_scc1 Lh_32
    s_branch Lj_33
Lh_32:
    s_mov_b32 s59, 0
    s_branch Lee_36
Le_34:
    buffer_load_dword v19, v13, s[28:31], s96 offen offset:512 sc1
    s_add_u32 s59, s59, 1
    s_waitcnt vmcnt(0)
Lee_36:
    v_xor_b32 v15, s99, v19
    v_lshlrev_b32 v15, 4, v15
    v_cmp_eq_u32 vcc, 0, v15
    v_cmp_eq_u32 s[60:61], s98, v19
    s_cmp_gt_u32 s59, 200000
    s_cbranch_scc1 Led_35
    s_cmp_lg_u32 vcc_lo, -1
    s_cbranch_scc1 Le_34
Led_35:
    s_cmp_lg_u32 s60, -1
    s_cselect_b32 s3, 1, 0
    v_mov_b32 v15, 162820
    v_mov_b32 v19, s3
    ds_write_b32 v15, v19
    v_mov_b32 v15, s99
    s_lshl_b32 s58, s101, 2
    s_add_u32 s58, s58, s96
    s_mov_b64 exec, 1
    s_cmp_lg_u32 s3, 0
    s_cbranch_scc1 Lps_39
    buffer_store_dword v15, v13, s[28:31], s58 offen offset:0
    s_branch Lpf_40
Lps_39:
    buffer_wbl2 sc1
    s_waitcnt vmcnt(0)
    buffer_store_dword v15, v13, s[28:31], s58 offen offset:0 sc1
Lpf_40:
    s_mov_b64 exec, -1
    s_and_b32 s61, s44, 3
    s_mul_i32 s60, s61, 7
    s_lshl_b32 s60, 0x7f, s60
    s_lshl_b32 s61, 0x10000000, s61
    s_or_b32 s60, s60, s61
    s_mov_b32 s61, 0
    s_mov_b32 s59, 0
Lp_37:
    buffer_load_dword v15, v13, s[28:31], s96 offen offset:0 sc1
    s_add_u32 s59, s59, 1
    s_waitcnt vmcnt(0)
    v_cmp_ne_u32 vcc, s99, v15
    s_cmp_gt_u32 s59, 200000
    s_cbranch_scc1 Lpd_38
    s_and_b64 vcc, vcc, s[60:61]
    s_cbranch_scc1 Lp_37
Lpd_38:
    s_cmp_eq_u32 s3, 0
    s_cbranch_scc1 Lpe_41
    buffer_inv sc1
    s_waitcnt vmcnt(0)
Lpe_41:
Lj_33:
L_qjoin:
    s_waitcnt lgkmcnt(0)
    s_barrier
    s_add_u32 m0, s53, 0
    s_xor_b32 s54, s52, 0
    buffer_load_dwordx4 v2, s[28:31], s54 offen offset:0 sc1 lds
    buffer_load_dwordx4 v2, s[28:31], s54 offen offset:1024 sc1 lds
    s_add_u32 m0, s53, 4096
    s_xor_b32 s54, s52, 4096
    buffer_load_dwordx4 v2, s[28:31], s54 offen offset:0 sc1 lds
    buffer_load_dwordx4 v2, s[28:31], s54 offen offset:1024 sc1 lds
    s_add_u32 m0, s53, 8192
    s_xor_b32 s54, s52, 8192
    buffer_load_dwordx4 v2, s[28:31], s54 offen offset:0 sc1 lds
    buffer_load_dwordx4 v2, s[28:31], s54 offen offset:1024 sc1 lds
    s_add_u32 m0, s53, 12288
    s_xor_b32 s54, s52, 12288
    buffer_load_dwordx4 v2, s[28:31], s54 offen offset:0 sc1 lds
    buffer_load_dwordx4 v2, s[28:31], s54 offen offset:1024 sc1 lds
    s_add_u32 s58, s100, 2
    s_and_b32 s58, s58, 7
    s_lshl3_add_u32 s58, s58, s26
    s_mul_i32 s87, s58, s24
    s_add_u32 m0, s86, 65536
    s_nop 0
    buffer_load_dwordx4 v20, s[40:43], s87 offen lds
    s_add_u32 m0, s86, 73728
    s_nop 0
    buffer_load_dwordx4 v21, s[92:95], s87 offen lds
    s_add_u32 s58, s100, 3
    s_and_b32 s58, s58, 7
    s_lshl3_add_u32 s58, s58, s26
    s_mul_i32 s87, s58, s24
    s_add_u32 m0, s86, 98304
    s_nop 0
    buffer_load_dwordx4 v20, s[40:43], s87 offen lds
    s_add_u32 m0, s86, 106496
    s_nop 0
    buffer_load_dwordx4 v21, s[92:95], s87 offen lds
    s_waitcnt vmcnt(10)
    s_barrier
    ds_read_b128 v[128:131], v8 offset:0
    ds_read_b128 v[132:135], v8 offset:16384
    ds_read_b128 v[136:139], v8 offset:1024
    ds_read_b128 v[140:143], v8 offset:17408
    ds_read_b128 v[144:147], v8 offset:2048
    ds_read_b128 v[148:151], v8 offset:18432
    ds_read_b128 v[152:155], v8 offset:3072
    ds_read_b128 v[156:159], v8 offset:19456
    s_cmp_lg_u32 s26, 5
    s_cbranch_scc1 Lo_42
    s_mul_i32 s10, s100, 278528
    s_lshl_b32 s11, s101, 13
    s_add_u32 s10, s10, s11
    s_add_u32 s10, s10, 16777216
    s_add_u32 s10, s28, s10
    s_addc_u32 s11, s29, 0
    global_load_dword v15, v14, s[10:11]
Lo_42:
    v_mov_b32 v12, 162820
    ds_read_b32 v12, v12
    v_lshlrev_b32 v220, 16, v200
    v_and_b32 v221, 0xffff0000, v200
    v_lshlrev_b32 v222, 16, v201
    v_and_b32 v223, 0xffff0000, v201
    v_lshlrev_b32 v224, 16, v202
    v_and_b32 v225, 0xffff0000, v202
    v_lshlrev_b32 v226, 16, v203
    v_and_b32 v227, 0xffff0000, v203
    v_lshlrev_b32 v204, 16, v216
    v_and_b32 v205, 0xffff0000, v216
    v_lshlrev_b32 v212, 16, v218
    v_and_b32 v213, 0xffff0000, v218
    v_lshlrev_b32 v206, 16, v217
    v_and_b32 v207, 0xffff0000, v217
    v_lshlrev_b32 v214, 16, v219
    v_and_b32 v215, 0xffff0000, v219
    s_waitcnt vmcnt(8)
    s_barrier
    ds_read_b128 v[160:163], v8 offset:4096
    ds_read_b128 v[164:167], v8 offset:20480
    ds_read_b128 v[168:171], v8 offset:5120
    ds_read_b128 v[172:175], v8 offset:21504
    ds_read_b128 v[176:179], v8 offset:6144
    ds_read_b128 v[180:183], v8 offset:22528
    ds_read_b128 v[184:187], v8 offset:7168
    ds_read_b128 v[188:191], v8 offset:23552
    s_waitcnt lgkmcnt(15)
    v_mfma_f32_16x16x32_bf16 v[192:195], v[64:67], v[128:131], 0
    v_mfma_f32_16x16x32_bf16 v[196:199], v[64:67], v[132:135], 0
    s_waitcnt lgkmcnt(14)
    v_mfma_f32_16x16x32_bf16 v[192:195], v[68:71], v[136:139], v[192:195]
    s_waitcnt lgkmcnt(13)
    v_mfma_f32_16x16x32_bf16 v[196:199], v[68:71], v[140:143], v[196:199]
    s_waitcnt lgkmcnt(12)
    v_mfma_f32_16x16x32_bf16 v[192:195], v[72:75], v[144:147], v[192:195]
    s_waitcnt lgkmcnt(11)
    v_mfma_f32_16x16x32_bf16 v[196:199], v[72:75], v[148:151], v[196:199]
    s_waitcnt lgkmcnt(10)
    v_mfma_f32_16x16x32_bf16 v[192:195], v[76:79], v[152:155], v[192:195]
    s_waitcnt lgkmcnt(9)
    v_mfma_f32_16x16x32_bf16 v[196:199], v[76:79], v[156:159], v[196:199]
    s_waitcnt vmcnt(6)
    s_barrier
    ds_read_b128 v[128:131], v8 offset:8192
    ds_read_b128 v[132:135], v8 offset:24576
    ds_read_b128 v[136:139], v8 offset:9216
    ds_read_b128 v[140:143], v8 offset:25600
    ds_read_b128 v[144:147], v8 offset:10240
    ds_read_b128 v[148:151], v8 offset:26624
    ds_read_b128 v[152:155], v8 offset:11264
    ds_read_b128 v[156:159], v8 offset:27648
    s_add_u32 s58, s100, 4
    s_and_b32 s58, s58, 7
    s_lshl3_add_u32 s58, s58, s26
    s_mul_i32 s87, s58, s24
    s_add_u32 m0, s86, 114688
    s_nop 0
    buffer_load_dwordx4 v20, s[40:43], s87 offen lds
    s_add_u32 m0, s86, 122880
    s_nop 0
    buffer_load_dwordx4 v21, s[92:95], s87 offen lds
    s_waitcnt lgkmcnt(15)
    v_mfma_f32_16x16x32_bf16 v[192:195], v[80:83], v[160:163], v[192:195]
    s_waitcnt lgkmcnt(14)
    v_mfma_f32_16x16x32_bf16 v[196:199], v[80:83], v[164:167], v[196:199]
    s_waitcnt lgkmcnt(13)
    v_mfma_f32_16x16x32_bf16 v[192:195], v[84:87], v[168:171], v[192:195]
    s_waitcnt lgkmcnt(12)
    v_mfma_f32_16x16x32_bf16 v[196:199], v[84:87], v[172:175], v[196:199]
    s_waitcnt lgkmcnt(11)
    v_mfma_f32_16x16x32_bf16 v[192:195], v[88:91], v[176:179], v[192:195]
    s_waitcnt lgkmcnt(10)
    v_mfma_f32_16x16x32_bf16 v[196:199], v[88:91], v[180:183], v[196:199]
    s_waitcnt lgkmcnt(9)
    v_mfma_f32_16x16x32_bf16 v[192:195], v[92:95], v[184:187], v[192:195]
    s_waitcnt lgkmcnt(8)
    v_mfma_f32_16x16x32_bf16 v[196:199], v[92:95], v[188:191], v[196:199]
    s_waitcnt vmcnt(6)
    s_barrier
    ds_read_b128 v[160:163], v8 offset:12288
    ds_read_b128 v[164:167], v8 offset:28672
    ds_read_b128 v[168:171], v8 offset:13312
    ds_read_b128 v[172:175], v8 offset:29696
    ds_read_b128 v[176:179], v8 offset:14336
    ds_read_b128 v[180:183], v8 offset:30720
    ds_read_b128 v[184:187], v8 offset:15360
    ds_read_b128 v[188:191], v8 offset:31744
    s_waitcnt lgkmcnt(15)
    v_mfma_f32_16x16x32_bf16 v[192:195], v[96:99], v[128:131], v[192:195]
    s_waitcnt lgkmcnt(14)
    v_mfma_f32_16x16x32_bf16 v[196:199], v[96:99], v[132:135], v[196:199]
    s_waitcnt lgkmcnt(13)
    v_mfma_f32_16x16x32_bf16 v[192:195], v[100:103], v[136:139], v[192:195]
    s_waitcnt lgkmcnt(12)
    v_mfma_f32_16x16x32_bf16 v[196:199], v[100:103], v[140:143], v[196:199]
    s_waitcnt lgkmcnt(11)
    v_mfma_f32_16x16x32_bf16 v[192:195], v[104:107], v[144:147], v[192:195]
    s_waitcnt lgkmcnt(10)
    v_mfma_f32_16x16x32_bf16 v[196:199], v[104:107], v[148:151], v[196:199]
    s_waitcnt lgkmcnt(9)
    v_mfma_f32_16x16x32_bf16 v[192:195], v[108:111], v[152:155], v[192:195]
    s_waitcnt lgkmcnt(8)
    v_mfma_f32_16x16x32_bf16 v[196:199], v[108:111], v[156:159], v[196:199]
    s_waitcnt lgkmcnt(7)
    v_mfma_f32_16x16x32_bf16 v[192:195], v[112:115], v[160:163], v[192:195]
    s_waitcnt lgkmcnt(6)
    v_mfma_f32_16x16x32_bf16 v[196:199], v[112:115], v[164:167], v[196:199]
    s_waitcnt lgkmcnt(5)
    v_mfma_f32_16x16x32_bf16 v[192:195], v[116:119], v[168:171], v[192:195]
    s_waitcnt lgkmcnt(4)
    v_mfma_f32_16x16x32_bf16 v[196:199], v[116:119], v[172:175], v[196:199]
    s_waitcnt lgkmcnt(3)
    v_mfma_f32_16x16x32_bf16 v[192:195], v[120:123], v[176:179], v[192:195]
    s_waitcnt lgkmcnt(2)
    v_mfma_f32_16x16x32_bf16 v[196:199], v[120:123], v[180:183], v[196:199]
    s_waitcnt lgkmcnt(1)
    v_mfma_f32_16x16x32_bf16 v[192:195], v[124:127], v[184:187], v[192:195]
    s_waitcnt lgkmcnt(0)
    v_mfma_f32_16x16x32_bf16 v[196:199], v[124:127], v[188:191], v[196:199]
    v_readfirstlane_b32 s3, v12
    v_and_b32 v12, 16, v1
    v_cmp_eq_u32 s[58:59], 0, v12
    s_nop 2
    v_fma_f32 v220, v192, v204, v220
    v_fma_f32 v221, v193, v205, v221
    v_fma_f32 v222, v194, v206, v222
    v_fma_f32 v223, v195, v207, v223
    v_fma_f32 v224, v196, v204, v224
    v_fma_f32 v225, v197, v205, v225
    v_fma_f32 v226, v198, v206, v226
    v_fma_f32 v227, v199, v207, v227
    v_cvt_pk_bf16_f32 v200, v220, v221
    v_cvt_pk_bf16_f32 v201, v222, v223
    v_cvt_pk_bf16_f32 v202, v224, v225
    v_cvt_pk_bf16_f32 v203, v226, v227
    v_lshlrev_b32 v220, 16, v200
    v_and_b32 v221, 0xffff0000, v200
    v_lshlrev_b32 v222, 16, v201
    v_and_b32 v223, 0xffff0000, v201
    v_lshlrev_b32 v224, 16, v202
    v_and_b32 v225, 0xffff0000, v202
    v_lshlrev_b32 v226, 16, v203
    v_and_b32 v227, 0xffff0000, v203
    v_mul_f32 v228, v220, v212
    v_mul_f32 v229, v221, v213
    v_mul_f32 v230, v222, v214
    v_mul_f32 v231, v223, v215
    v_mul_f32 v232, v224, v212
    v_mul_f32 v233, v225, v213
    v_mul_f32 v234, v226, v214
    v_mul_f32 v235, v227, v215
    v_cvt_pk_bf16_f32 v236, v228, v229
    v_cvt_pk_bf16_f32 v237, v230, v231
    v_cvt_pk_bf16_f32 v238, v232, v233
    v_cvt_pk_bf16_f32 v239, v234, v235
    s_nop 0
    v_permlane32_swap_b32 v236, v238
    v_permlane32_swap_b32 v237, v239
    buffer_store_dwordx4 v[236:239], v10, s[28:31], s56 offen
    v_add_f32 v240, v220, v221
    v_mul_f32 v241, v220, v220
    v_add_f32 v240, v240, v222
    v_fmac_f32 v241, v221, v221
    v_add_f32 v240, v240, v223
    v_fmac_f32 v241, v222, v222
    v_fmac_f32 v241, v223, v223
    v_add_f32 v242, v224, v225
    v_mul_f32 v243, v224, v224
    v_add_f32 v242, v242, v226
    v_fmac_f32 v243, v225, v225
    v_add_f32 v242, v242, v227
    v_fmac_f32 v243, v226, v226
    v_fmac_f32 v243, v227, v227
    v_permlane32_swap_b32 v240, v242
    s_nop 0
    v_permlane32_swap_b32 v241, v243
    v_add_f32 v240, v240, v242
    v_add_f32 v241, v241, v243
    v_mov_b32 v242, v240
    v_mov_b32 v243, v241
    s_nop 0
    v_permlane16_swap_b32 v240, v242
    v_permlane16_swap_b32 v241, v243
    v_add_f32 v240, v240, v242
    v_add_f32 v241, v241, v243
    s_mov_b64 exec, s[58:59]
    buffer_store_dwordx2 v[240:241], v11, s[28:31], s57 offen
    s_mov_b64 exec, -1
    v_permlane16_swap_b32 v200, v202
    v_permlane16_swap_b32 v201, v203
    v_mov_b32 v16, v200
    v_mov_b32 v17, v201
    v_mov_b32 v18, v202
    v_mov_b32 v19, v203
    s_cmp_ge_u32 s101, 28
    s_cbranch_scc1 L_pf
    s_waitcnt vmcnt(0) lgkmcnt(0)
    s_barrier
    s_cmp_eq_u32 s26, 7
    s_cbranch_scc1 Lh_43
    s_add_u32 s58, s100, 5
    s_and_b32 s58, s58, 7
    s_lshl3_add_u32 s58, s58, s26
    s_mul_i32 s87, s58, s24
    s_add_u32 m0, s86, 0
    s_nop 0
    buffer_load_dwordx4 v20, s[40:43], s87 offen lds
    s_add_u32 m0, s86, 8192
    s_nop 0
    buffer_load_dwordx4 v21, s[92:95], s87 offen lds
    s_lshl_b32 s53, s100, 3
    s_add_u32 s53, s53, s26
    s_lshl_b32 s52, s26, 15
    s_mul_i32 s54, s100, 278528
    s_add_u32 s52, s52, s54
    s_add_u32 s52, s52, 16777216
    v_mov_b32 v30, v14
    v_lshrrev_b32 v28, 5, v1
    v_bfe_u32 v32, v1, 2, 2
    v_lshl_add_u32 v33, v28, 2, v32
    v_lshlrev_b32 v33, 7, v33
    v_bfe_u32 v34, v1, 4, 1
    v_lshl_add_u32 v33, v34, 13, v33
    v_bfe_u32 v34, v1, 3, 2
    v_xor_b32 v34, s27, v34
    v_lshl_add_u32 v33, v34, 5, v33
    v_and_b32 v34, 3, v1
    v_lshl_add_u32 v33, v34, 3, v33
    v_add_u32 v22, 139264, v33
    v_xor_b32 v23, 32, v22
    v_xor_b32 v24, 64, v22
    v_xor_b32 v25, 96, v22
    v_bfe_u32 v29, v1, 1, 1
    v_lshlrev_b32 v29, 10, v29
    v_lshl_add_u32 v29, v28, 4, v29
    v_add_u32 v29, 155648, v29
    v_lshrrev_b32 v32, 4, v1
    v_xor_b32 v32, v32, v1
    v_and_b32 v32, 1, v32
    v_cmp_eq_u32 vcc, 1, v32
    v_mov_b32 v32, 159744
    s_nop 0
    v_cndmask_b32 v29, v29, v32, vcc
    v_lshrrev_b32 v32, 3, v1
    v_and_b32 v33, 7, v1
    v_bfe_u32 v34, v32, 1, 1
    v_lshlrev_b32 v34, 2, v34
    v_xor_b32 v33, v33, v34
    v_lshlrev_b32 v3, 10, v32
    v_lshl_add_u32 v3, v33, 4, v3
    s_mov_b32 s32, s16
    s_mov_b32 s33, s17
    s_mov_b32 s34, 1835008
    s_mov_b32 s35, 0x20000
    s_lshr_b32 s47, s26, 1
    s_mul_i32 s48, s47, 458752
    s_and_b32 s46, s26, 1
    s_lshl_b32 s51, s46, 13
    s_add_u32 s48, s48, s51
    s_lshl_b32 s51, s45, 7
    s_add_u32 s48, s48, s51
    v_lshrrev_b32 v32, 5, v1
    v_bfe_u32 v33, v1, 2, 2
    v_lshl_add_u32 v32, v32, 2, v33
    v_lshlrev_b32 v26, 7, v32
    v_lshrrev_b32 v33, 1, v33
    v_lshl_add_u32 v26, v33, 6, v26
    v_bfe_u32 v33, v1, 4, 1
    v_lshl_add_u32 v26, v33, 5, v26
    v_and_b32 v33, 3, v1
    v_lshl_add_u32 v26, v33, 3, v26
    s_lshl_b32 s50, s47, 11
    s_add_u32 s50, s50, 65536
    v_add_u32 v26, s50, v26
    v_xor_b32 v27, 64, v26
    s_lshl_b32 s51, s44, 1
    s_add_u32 s51, s51, s46
    s_lshl_b32 s51, s51, 2
    s_add_u32 s51, s51, s47
    s_mul_i32 s51, s51, 28672
    s_add_u32 s51, s51, 9437184
    s_branch Lj_44
Lh_43:
    v_mov_b32 v15, s99
    s_lshl_b32 s58, s101, 2
    s_add_u32 s58, s58, s96
    s_mov_b64 exec, 1
    s_cmp_lg_u32 s3, 0
    s_cbranch_scc1 Lps_47
    buffer_store_dword v15, v13, s[28:31], s58 offen offset:128
    s_branch Lpf_48
Lps_47:
    buffer_wbl2 sc1
    s_waitcnt vmcnt(0)
    buffer_store_dword v15, v13, s[28:31], s58 offen offset:128 sc1
Lpf_48:
    s_mov_b64 exec, -1
    v_mov_b32 v52, 0
    v_mov_b32 v53, 0
    v_mov_b32 v54, 0
    v_mov_b32 v55, 0
    v_add_u32 v49, 159744, v2
    ds_write_b128 v49, v[52:55]
    s_add_u32 s58, s100, 5
    s_and_b32 s58, s58, 7
    s_lshl3_add_u32 s58, s58, s26
    s_mul_i32 s87, s58, s24
    s_add_u32 m0, s86, 0
    s_nop 0
    buffer_load_dwordx4 v20, s[40:43], s87 offen lds
    s_add_u32 m0, s86, 8192
    s_nop 0
    buffer_load_dwordx4 v21, s[92:95], s87 offen lds
    s_lshl_b32 s53, s100, 3
    s_add_u32 s53, s53, s26
    s_lshl_b32 s52, s26, 15
    s_mul_i32 s54, s100, 278528
    s_add_u32 s52, s52, s54
    s_add_u32 s52, s52, 16777216
    v_mov_b32 v30, v14
    v_lshrrev_b32 v28, 5, v1
    v_bfe_u32 v32, v1, 2, 2
    v_lshl_add_u32 v33, v28, 2, v32
    v_lshlrev_b32 v33, 7, v33
    v_bfe_u32 v34, v1, 4, 1
    v_lshl_add_u32 v33, v34, 13, v33
    v_bfe_u32 v34, v1, 3, 2
    v_xor_b32 v34, s27, v34
    v_lshl_add_u32 v33, v34, 5, v33
    v_and_b32 v34, 3, v1
    v_lshl_add_u32 v33, v34, 3, v33
    v_add_u32 v22, 139264, v33
    v_xor_b32 v23, 32, v22
    v_xor_b32 v24, 64, v22
    v_xor_b32 v25, 96, v22
    v_bfe_u32 v29, v1, 1, 1
    v_lshlrev_b32 v29, 10, v29
    v_lshl_add_u32 v29, v28, 4, v29
    v_add_u32 v29, 155648, v29
    v_lshrrev_b32 v32, 4, v1
    v_xor_b32 v32, v32, v1
    v_and_b32 v32, 1, v32
    v_cmp_eq_u32 vcc, 1, v32
    v_mov_b32 v32, 159744
    s_nop 0
    v_cndmask_b32 v29, v29, v32, vcc
    v_lshrrev_b32 v32, 3, v1
    v_and_b32 v33, 7, v1
    v_bfe_u32 v34, v32, 1, 1
    v_lshlrev_b32 v34, 2, v34
    v_xor_b32 v33, v33, v34
    v_lshlrev_b32 v3, 10, v32
    v_lshl_add_u32 v3, v33, 4, v3
    s_mov_b32 s32, s16
    s_mov_b32 s33, s17
    s_mov_b32 s34, 1835008
    s_mov_b32 s35, 0x20000
    s_lshr_b32 s47, s26, 1
    s_mul_i32 s48, s47, 458752
    s_and_b32 s46, s26, 1
    s_lshl_b32 s51, s46, 13
    s_add_u32 s48, s48, s51
    s_lshl_b32 s51, s45, 7
    s_add_u32 s48, s48, s51
    v_lshrrev_b32 v32, 5, v1
    v_bfe_u32 v33, v1, 2, 2
    v_lshl_add_u32 v32, v32, 2, v33
    v_lshlrev_b32 v26, 7, v32
    v_lshrrev_b32 v33, 1, v33
    v_lshl_add_u32 v26, v33, 6, v26
    v_bfe_u32 v33, v1, 4, 1
    v_lshl_add_u32 v26, v33, 5, v26
    v_and_b32 v33, 3, v1
    v_lshl_add_u32 v26, v33, 3, v26
    s_lshl_b32 s50, s47, 11
    s_add_u32 s50, s50, 65536
    v_add_u32 v26, s50, v26
    v_xor_b32 v27, 64, v26
    s_lshl_b32 s51, s44, 1
    s_add_u32 s51, s51, s46
    s_lshl_b32 s51, s51, 2
    s_add_u32 s51, s51, s47
    s_mul_i32 s51, s51, 28672
    s_add_u32 s51, s51, 9437184
    s_mov_b32 s60, 0xffffffff
    s_mov_b32 s61, 0
    s_mov_b32 s59, 0
Lp_45:
    buffer_load_dword v15, v13, s[28:31], s96 offen offset:128 sc1
    s_add_u32 s59, s59, 1
    s_waitcnt vmcnt(0)
    v_cmp_ne_u32 vcc, s99, v15
    s_cmp_gt_u32 s59, 200000
    s_cbranch_scc1 Lpd_46
    s_and_b64 vcc, vcc, s[60:61]
    s_cbranch_scc1 Lp_45
Lpd_46:
    s_cmp_eq_u32 s3, 0
    s_cbranch_scc1 Lpe_49
    buffer_inv sc1
    s_waitcnt vmcnt(0)
Lpe_49:
Lj_44:
    s_barrier
    s_lshl_b32 s54, s26, 8
    s_add_u32 m0, s54, 155648
    s_add_u32 s54, s54, s97
    s_add_u32 s54, s54, 4096
    s_mov_b64 exec, 0xffff
    buffer_load_dwordx4 v2, s[28:31], s54 offen sc1 lds
    s_mov_b64 exec, -1
    s_add_u32 s54, s100, 0
    s_and_b32 s54, s54, 7
    s_lshl_b32 s54, s54, 12
    s_add_u32 s54, s54, s52
    buffer_load_dwordx4 v[128:131], v2, s[28:31], s54 offen offset:0 sc1
    buffer_load_dwordx4 v[132:135], v2, s[28:31], s54 offen offset:1024 sc1
    buffer_load_dwordx4 v[136:139], v2, s[28:31], s54 offen offset:2048 sc1
    buffer_load_dwordx4 v[140:143], v2, s[28:31], s54 offen offset:3072 sc1
    s_add_u32 s54, s100, 1
    s_and_b32 s54, s54, 7
    s_lshl_b32 s54, s54, 12
    s_add_u32 s54, s54, s52
    buffer_load_dwordx4 v[144:147], v2, s[28:31], s54 offen offset:0 sc1
    buffer_load_dwordx4 v[148:151], v2, s[28:31], s54 offen offset:1024 sc1
    buffer_load_dwordx4 v[152:155], v2, s[28:31], s54 offen offset:2048 sc1
    buffer_load_dwordx4 v[156:159], v2, s[28:31], s54 offen offset:3072 sc1
    s_cmp_ge_u32 s26, 4
    s_cselect_b64 vcc, -1, 0
    s_waitcnt vmcnt(8) lgkmcnt(0)
    s_barrier
    ds_read_b64_tr_b16 v[32:33], v22 offset:0
    ds_read_b64_tr_b16 v[34:35], v22 offset:1024
    ds_read_b64_tr_b16 v[36:37], v23 offset:0
    ds_read_b64_tr_b16 v[38:39], v23 offset:1024
    ds_read_b128 v[4:7], v29 offset:0
    ds_read_b64_tr_b16 v[40:41], v24 offset:0
    ds_read_b64_tr_b16 v[42:43], v24 offset:1024
    ds_read_b64_tr_b16 v[44:45], v25 offset:0
    ds_read_b64_tr_b16 v[46:47], v25 offset:1024
    s_waitcnt vmcnt(7) lgkmcnt(7)
    v_mfma_f32_32x32x16_bf16 v[64:79], v[32:35], v[128:131], 0
    ds_read_b64_tr_b16 v[48:49], v22 offset:2048
    ds_read_b64_tr_b16 v[50:51], v22 offset:3072
    s_add_u32 s54, s100, 2
    s_and_b32 s54, s54, 7
    s_lshl_b32 s54, s54, 12
    s_add_u32 s54, s54, s52
    buffer_load_dwordx4 v[160:163], v2, s[28:31], s54 offen offset:0 sc1
    s_waitcnt lgkmcnt(7)
    v_mfma_f32_32x32x16_bf16 v[80:95], v[36:39], v[128:131], 0
    ds_read_b64_tr_b16 v[52:53], v23 offset:2048
    ds_read_b64_tr_b16 v[54:55], v23 offset:3072
    ds_read_b128 v[8:11], v29 offset:32
    s_waitcnt lgkmcnt(7)
    v_mfma_f32_32x32x16_bf16 v[96:111], v[40:43], v[128:131], 0
    ds_read_b64_tr_b16 v[56:57], v24 offset:2048
    ds_read_b64_tr_b16 v[58:59], v24 offset:3072
    s_cbranch_vccnz Lu_50
    v_mfma_f32_16x16x32_bf16 v[12:15], v[32:35], v[4:7], 0
Lu_50:
    s_waitcnt lgkmcnt(7)
    v_mfma_f32_32x32x16_bf16 v[112:127], v[44:47], v[128:131], 0
    ds_read_b64_tr_b16 v[60:61], v25 offset:2048
    ds_read_b64_tr_b16 v[62:63], v25 offset:3072
    s_waitcnt vmcnt(7) lgkmcnt(7)
    v_mfma_f32_32x32x16_bf16 v[64:79], v[48:51], v[132:135], v[64:79]
    ds_read_b64_tr_b16 v[32:33], v22 offset:4096
    ds_read_b64_tr_b16 v[34:35], v22 offset:5120
    buffer_load_dwordx4 v[164:167], v2, s[28:31], s54 offen offset:1024 sc1
    s_waitcnt lgkmcnt(7)
    v_mfma_f32_32x32x16_bf16 v[80:95], v[52:55], v[132:135], v[80:95]
    ds_read_b64_tr_b16 v[36:37], v23 offset:4096
    ds_read_b64_tr_b16 v[38:39], v23 offset:5120
    ds_read_b128 v[4:7], v29 offset:64
    s_waitcnt lgkmcnt(7)
    v_mfma_f32_32x32x16_bf16 v[96:111], v[56:59], v[132:135], v[96:111]
    ds_read_b64_tr_b16 v[40:41], v24 offset:4096
    ds_read_b64_tr_b16 v[42:43], v24 offset:5120
    s_cbranch_vccnz Lu_51
    v_mfma_f32_16x16x32_bf16 v[12:15], v[48:51], v[8:11], v[12:15]
Lu_51:
    s_waitcnt lgkmcnt(7)
    v_mfma_f32_32x32x16_bf16 v[112:127], v[60:63], v[132:135], v[112:127]
    ds_read_b64_tr_b16 v[44:45], v25 offset:4096
    ds_read_b64_tr_b16 v[46:47], v25 offset:5120
    s_add_u32 s58, s100, 6
    s_and_b32 s58, s58, 7
    s_lshl3_add_u32 s58, s58, s26
    s_mul_i32 s87, s58, s24
    s_add_u32 m0, s86, 16384
    s_nop 0
    buffer_load_dwordx4 v20, s[40:43], s87 offen lds
    s_add_u32 m0, s86, 24576
    s_nop 0
    buffer_load_dwordx4 v21, s[92:95], s87 offen lds
    s_waitcnt vmcnt(9) lgkmcnt(7)
    v_mfma_f32_32x32x16_bf16 v[64:79], v[32:35], v[136:139], v[64:79]
    ds_read_b64_tr_b16 v[48:49], v22 offset:6144
    ds_read_b64_tr_b16 v[50:51], v22 offset:7168
    buffer_load_dwordx4 v[168:171], v2, s[28:31], s54 offen offset:2048 sc1
    s_waitcnt lgkmcnt(7)
    v_mfma_f32_32x32x16_bf16 v[80:95], v[36:39], v[136:139], v[80:95]
    ds_read_b64_tr_b16 v[52:53], v23 offset:6144
    ds_read_b64_tr_b16 v[54:55], v23 offset:7168
    ds_read_b128 v[8:11], v29 offset:96
    s_waitcnt lgkmcnt(7)
    v_mfma_f32_32x32x16_bf16 v[96:111], v[40:43], v[136:139], v[96:111]
    ds_read_b64_tr_b16 v[56:57], v24 offset:6144
    ds_read_b64_tr_b16 v[58:59], v24 offset:7168
    s_cbranch_vccnz Lu_52
    v_mfma_f32_16x16x32_bf16 v[12:15], v[32:35], v[4:7], v[12:15]
Lu_52:
    s_waitcnt lgkmcnt(7)
    v_mfma_f32_32x32x16_bf16 v[112:127], v[44:47], v[136:139], v[112:127]
    ds_read_b64_tr_b16 v[60:61], v25 offset:6144
    ds_read_b64_tr_b16 v[62:63], v25 offset:7168
    s_waitcnt lgkmcnt(0)
    v_add_u32 v22, 0xffff2000, v22
    v_add_u32 v23, 0xffff2000, v23
    v_add_u32 v24, 0xffff2000, v24
    v_add_u32 v25, 0xffff2000, v25
    s_barrier
    s_waitcnt vmcnt(9)
    v_mfma_f32_32x32x16_bf16 v[64:79], v[48:51], v[140:143], v[64:79]
    ds_read_b64_tr_b16 v[32:33], v22 offset:0
    ds_read_b64_tr_b16 v[34:35], v22 offset:1024
    buffer_load_dwordx4 v[172:175], v2, s[28:31], s54 offen offset:3072 sc1
    v_mfma_f32_32x32x16_bf16 v[80:95], v[52:55], v[140:143], v[80:95]
    ds_read_b64_tr_b16 v[36:37], v23 offset:0
    ds_read_b64_tr_b16 v[38:39], v23 offset:1024
    ds_read_b128 v[4:7], v29 offset:128
    v_mfma_f32_32x32x16_bf16 v[96:111], v[56:59], v[140:143], v[96:111]
    ds_read_b64_tr_b16 v[40:41], v24 offset:0
    ds_read_b64_tr_b16 v[42:43], v24 offset:1024
    s_cbranch_vccnz Lu_53
    v_mfma_f32_16x16x32_bf16 v[12:15], v[48:51], v[8:11], v[12:15]
Lu_53:
    v_mfma_f32_32x32x16_bf16 v[112:127], v[60:63], v[140:143], v[112:127]
    ds_read_b64_tr_b16 v[44:45], v25 offset:0
    ds_read_b64_tr_b16 v[46:47], v25 offset:1024
    s_waitcnt vmcnt(9) lgkmcnt(7)
    v_mfma_f32_32x32x16_bf16 v[64:79], v[32:35], v[144:147], v[64:79]
    ds_read_b64_tr_b16 v[48:49], v22 offset:2048
    ds_read_b64_tr_b16 v[50:51], v22 offset:3072
    s_add_u32 s54, s100, 3
    s_and_b32 s54, s54, 7
    s_lshl_b32 s54, s54, 12
    s_add_u32 s54, s54, s52
    buffer_load_dwordx4 v[176:179], v2, s[28:31], s54 offen offset:0 sc1
    s_waitcnt lgkmcnt(7)
    v_mfma_f32_32x32x16_bf16 v[80:95], v[36:39], v[144:147], v[80:95]
    ds_read_b64_tr_b16 v[52:53], v23 offset:2048
    ds_read_b64_tr_b16 v[54:55], v23 offset:3072
    ds_read_b128 v[8:11], v29 offset:160
    s_waitcnt lgkmcnt(7)
    v_mfma_f32_32x32x16_bf16 v[96:111], v[40:43], v[144:147], v[96:111]
    ds_read_b64_tr_b16 v[56:57], v24 offset:2048
    ds_read_b64_tr_b16 v[58:59], v24 offset:3072
    s_cbranch_vccnz Lu_54
    v_mfma_f32_16x16x32_bf16 v[12:15], v[32:35], v[4:7], v[12:15]
Lu_54:
    s_waitcnt lgkmcnt(7)
    v_mfma_f32_32x32x16_bf16 v[112:127], v[44:47], v[144:147], v[112:127]
    ds_read_b64_tr_b16 v[60:61], v25 offset:2048
    ds_read_b64_tr_b16 v[62:63], v25 offset:3072
    s_waitcnt vmcnt(9) lgkmcnt(7)
    v_mfma_f32_32x32x16_bf16 v[64:79], v[48:51], v[148:151], v[64:79]
    ds_read_b64_tr_b16 v[32:33], v22 offset:4096
    ds_read_b64_tr_b16 v[34:35], v22 offset:5120
    buffer_load_dwordx4 v[180:183], v2, s[28:31], s54 offen offset:1024 sc1
    s_waitcnt lgkmcnt(7)
    v_mfma_f32_32x32x16_bf16 v[80:95], v[52:55], v[148:151], v[80:95]
    ds_read_b64_tr_b16 v[36:37], v23 offset:4096
    ds_read_b64_tr_b16 v[38:39], v23 offset:5120
    ds_read_b128 v[4:7], v29 offset:192
    s_waitcnt lgkmcnt(7)
    v_mfma_f32_32x32x16_bf16 v[96:111], v[56:59], v[148:151], v[96:111]
    ds_read_b64_tr_b16 v[40:41], v24 offset:4096
    ds_read_b64_tr_b16 v[42:43], v24 offset:5120
    s_cbranch_vccnz Lu_55
    v_mfma_f32_16x16x32_bf16 v[12:15], v[48:51], v[8:11], v[12:15]
Lu_55:
    s_waitcnt lgkmcnt(7)
    v_mfma_f32_32x32x16_bf16 v[112:127], v[60:63], v[148:151], v[112:127]
    ds_read_b64_tr_b16 v[44:45], v25 offset:4096
    ds_read_b64_tr_b16 v[46:47], v25 offset:5120
    s_add_u32 s58, s100, 7
    s_and_b32 s58, s58, 7
    s_lshl3_add_u32 s58, s58, s26
    s_mul_i32 s87, s58, s24
    s_add_u32 m0, s86, 32768
    s_nop 0
    buffer_load_dwordx4 v20, s[40:43], s87 offen lds
    s_add_u32 m0, s86, 40960
    s_nop 0
    buffer_load_dwordx4 v21, s[92:95], s87 offen lds
    s_waitcnt vmcnt(11) lgkmcnt(7)
    v_mfma_f32_32x32x16_bf16 v[64:79], v[32:35], v[152:155], v[64:79]
    ds_read_b64_tr_b16 v[48:49], v22 offset:6144
    ds_read_b64_tr_b16 v[50:51], v22 offset:7168
    buffer_load_dwordx4 v[184:187], v2, s[28:31], s54 offen offset:2048 sc1
    s_waitcnt lgkmcnt(7)
    v_mfma_f32_32x32x16_bf16 v[80:95], v[36:39], v[152:155], v[80:95]
    ds_read_b64_tr_b16 v[52:53], v23 offset:6144
    ds_read_b64_tr_b16 v[54:55], v23 offset:7168
    ds_read_b128 v[8:11], v29 offset:224
    s_waitcnt lgkmcnt(7)
    v_mfma_f32_32x32x16_bf16 v[96:111], v[40:43], v[152:155], v[96:111]
    ds_read_b64_tr_b16 v[56:57], v24 offset:6144
    ds_read_b64_tr_b16 v[58:59], v24 offset:7168
    s_cbranch_vccnz Lu_56
    v_mfma_f32_16x16x32_bf16 v[12:15], v[32:35], v[4:7], v[12:15]
Lu_56:
    s_waitcnt lgkmcnt(7)
    v_mfma_f32_32x32x16_bf16 v[112:127], v[44:47], v[152:155], v[112:127]
    ds_read_b64_tr_b16 v[60:61], v25 offset:6144
    ds_read_b64_tr_b16 v[62:63], v25 offset:7168
    s_waitcnt lgkmcnt(0)
    v_add_u32 v22, 0xffffc000, v22
    v_add_u32 v23, 0xffffc000, v23
    v_add_u32 v24, 0xffffc000, v24
    v_add_u32 v25, 0xffffc000, v25
    s_barrier
    s_waitcnt vmcnt(11)
    v_mfma_f32_32x32x16_bf16 v[64:79], v[48:51], v[156:159], v[64:79]
    ds_read_b64_tr_b16 v[32:33], v22 offset:0
    ds_read_b64_tr_b16 v[34:35], v22 offset:1024
    buffer_load_dwordx4 v[188:191], v2, s[28:31], s54 offen offset:3072 sc1
    v_mfma_f32_32x32x16_bf16 v[80:95], v[52:55], v[156:159], v[80:95]
    ds_read_b64_tr_b16 v[36:37], v23 offset:0
    ds_read_b64_tr_b16 v[38:39], v23 offset:1024
    ds_read_b128 v[4:7], v29 offset:256
    v_mfma_f32_32x32x16_bf16 v[96:111], v[56:59], v[156:159], v[96:111]
    ds_read_b64_tr_b16 v[40:41], v24 offset:0
    ds_read_b64_tr_b16 v[42:43], v24 offset:1024
    s_cbranch_vccnz Lu_57
    v_mfma_f32_16x16x32_bf16 v[12:15], v[48:51], v[8:11], v[12:15]
Lu_57:
    v_mfma_f32_32x32x16_bf16 v[112:127], v[60:63], v[156:159], v[112:127]
    ds_read_b64_tr_b16 v[44:45], v25 offset:0
    ds_read_b64_tr_b16 v[46:47], v25 offset:1024
    s_add_u32 s49, s25, 0
    s_cmp_ge_u32 s49, 7
    s_cselect_b32 s87, 7, 0
    s_sub_u32 s49, s49, s87
    s_lshl_b32 s49, s49, 16
    s_add_u32 s49, s49, s48
    s_add_u32 m0, s86, 49152
    s_add_u32 s50, s49, 0
    buffer_load_dwordx4 v3, s[32:35], s50 offen lds
    s_waitcnt vmcnt(12) lgkmcnt(7)
    v_mfma_f32_32x32x16_bf16 v[64:79], v[32:35], v[160:163], v[64:79]
    ds_read_b64_tr_b16 v[48:49], v22 offset:2048
    ds_read_b64_tr_b16 v[50:51], v22 offset:3072
    s_add_u32 s54, s100, 4
    s_and_b32 s54, s54, 7
    s_lshl_b32 s54, s54, 12
    s_add_u32 s54, s54, s52
    buffer_load_dwordx4 v[192:195], v2, s[28:31], s54 offen offset:0 sc1
    s_waitcnt lgkmcnt(7)
    v_mfma_f32_32x32x16_bf16 v[80:95], v[36:39], v[160:163], v[80:95]
    ds_read_b64_tr_b16 v[52:53], v23 offset:2048
    ds_read_b64_tr_b16 v[54:55], v23 offset:3072
    ds_read_b128 v[8:11], v29 offset:288
    s_waitcnt lgkmcnt(7)
    v_mfma_f32_32x32x16_bf16 v[96:111], v[40:43], v[160:163], v[96:111]
    ds_read_b64_tr_b16 v[56:57], v24 offset:2048
    ds_read_b64_tr_b16 v[58:59], v24 offset:3072
    s_cbranch_vccnz Lu_58
    v_mfma_f32_16x16x32_bf16 v[12:15], v[32:35], v[4:7], v[12:15]
Lu_58:
    s_waitcnt lgkmcnt(7)
    v_mfma_f32_32x32x16_bf16 v[112:127], v[44:47], v[160:163], v[112:127]
    ds_read_b64_tr_b16 v[60:61], v25 offset:2048
    ds_read_b64_tr_b16 v[62:63], v25 offset:3072
    s_add_u32 m0, s86, 57344
    s_add_u32 s50, s49, 16384
    buffer_load_dwordx4 v3, s[32:35], s50 offen lds
    s_waitcnt vmcnt(13) lgkmcnt(7)
    v_mfma_f32_32x32x16_bf16 v[64:79], v[48:51], v[164:167], v[64:79]
    ds_read_b64_tr_b16 v[32:33], v22 offset:4096
    ds_read_b64_tr_b16 v[34:35], v22 offset:5120
    buffer_load_dwordx4 v[196:199], v2, s[28:31], s54 offen offset:1024 sc1
    s_waitcnt lgkmcnt(7)
    v_mfma_f32_32x32x16_bf16 v[80:95], v[52:55], v[164:167], v[80:95]
    ds_read_b64_tr_b16 v[36:37], v23 offset:4096
    ds_read_b64_tr_b16 v[38:39], v23 offset:5120
    ds_read_b128 v[4:7], v29 offset:320
    s_waitcnt lgkmcnt(7)
    v_mfma_f32_32x32x16_bf16 v[96:111], v[56:59], v[164:167], v[96:111]
    ds_read_b64_tr_b16 v[40:41], v24 offset:4096
    ds_read_b64_tr_b16 v[42:43], v24 offset:5120
    s_cbranch_vccnz Lu_59
    v_mfma_f32_16x16x32_bf16 v[12:15], v[48:51], v[8:11], v[12:15]
Lu_59:
    s_waitcnt lgkmcnt(7)
    v_mfma_f32_32x32x16_bf16 v[112:127], v[60:63], v[164:167], v[112:127]
    ds_read_b64_tr_b16 v[44:45], v25 offset:4096
    ds_read_b64_tr_b16 v[46:47], v25 offset:5120
    s_add_u32 m0, s86, 131072
    s_add_u32 s50, s49, 32768
    buffer_load_dwordx4 v3, s[32:35], s50 offen lds
    s_waitcnt vmcnt(12) lgkmcnt(7)
    v_mfma_f32_32x32x16_bf16 v[64:79], v[32:35], v[168:171], v[64:79]
    ds_read_b64_tr_b16 v[48:49], v22 offset:6144
    ds_read_b64_tr_b16 v[50:51], v22 offset:7168
    buffer_load_dwordx4 v[200:203], v2, s[28:31], s54 offen offset:2048 sc1
    s_waitcnt lgkmcnt(7)
    v_mfma_f32_32x32x16_bf16 v[80:95], v[36:39], v[168:171], v[80:95]
    ds_read_b64_tr_b16 v[52:53], v23 offset:6144
    ds_read_b64_tr_b16 v[54:55], v23 offset:7168
    ds_read_b128 v[8:11], v29 offset:352
    s_waitcnt lgkmcnt(7)
    v_mfma_f32_32x32x16_bf16 v[96:111], v[40:43], v[168:171], v[96:111]
    ds_read_b64_tr_b16 v[56:57], v24 offset:6144
    ds_read_b64_tr_b16 v[58:59], v24 offset:7168
    s_cbranch_vccnz Lu_60
    v_mfma_f32_16x16x32_bf16 v[12:15], v[32:35], v[4:7], v[12:15]
Lu_60:
    s_waitcnt lgkmcnt(7)
    v_mfma_f32_32x32x16_bf16 v[112:127], v[44:47], v[168:171], v[112:127]
    ds_read_b64_tr_b16 v[60:61], v25 offset:6144
    ds_read_b64_tr_b16 v[62:63], v25 offset:7168
    s_add_u32 m0, s86, 139264
    s_add_u32 s50, s49, 49152
    buffer_load_dwordx4 v3, s[32:35], s50 offen lds
    s_waitcnt lgkmcnt(0)
    v_add_u32 v22, 0x8000, v22
    v_add_u32 v23, 0x8000, v23
    v_add_u32 v24, 0x8000, v24
    v_add_u32 v25, 0x8000, v25
    s_barrier
    s_waitcnt vmcnt(13)
    v_mfma_f32_32x32x16_bf16 v[64:79], v[48:51], v[172:175], v[64:79]
    ds_read_b64_tr_b16 v[32:33], v22 offset:0
    ds_read_b64_tr_b16 v[34:35], v22 offset:1024
    buffer_load_dwordx4 v[204:207], v2, s[28:31], s54 offen offset:3072 sc1
    v_mfma_f32_32x32x16_bf16 v[80:95], v[52:55], v[172:175], v[80:95]
    ds_read_b64_tr_b16 v[36:37], v23 offset:0
    ds_read_b64_tr_b16 v[38:39], v23 offset:1024
    ds_read_b128 v[4:7], v29 offset:384
    v_mfma_f32_32x32x16_bf16 v[96:111], v[56:59], v[172:175], v[96:111]
    ds_read_b64_tr_b16 v[40:41], v24 offset:0
    ds_read_b64_tr_b16 v[42:43], v24 offset:1024
    s_cbranch_vccnz Lu_61
    v_mfma_f32_16x16x32_bf16 v[12:15], v[48:51], v[8:11], v[12:15]
Lu_61:
    v_mfma_f32_32x32x16_bf16 v[112:127], v[60:63], v[172:175], v[112:127]
    ds_read_b64_tr_b16 v[44:45], v25 offset:0
    ds_read_b64_tr_b16 v[46:47], v25 offset:1024
    s_add_u32 s49, s25, 1
    s_cmp_ge_u32 s49, 7
    s_cselect_b32 s87, 7, 0
    s_sub_u32 s49, s49, s87
    s_lshl_b32 s49, s49, 16
    s_add_u32 s49, s49, s48
    s_add_u32 m0, s86, 147456
    s_add_u32 s50, s49, 0
    buffer_load_dwordx4 v3, s[32:35], s50 offen lds
    s_waitcnt vmcnt(14) lgkmcnt(7)
    v_mfma_f32_32x32x16_bf16 v[64:79], v[32:35], v[176:179], v[64:79]
    ds_read_b64_tr_b16 v[48:49], v22 offset:2048
    ds_read_b64_tr_b16 v[50:51], v22 offset:3072
    s_add_u32 s54, s100, 5
    s_and_b32 s54, s54, 7
    s_lshl_b32 s54, s54, 12
    s_add_u32 s54, s54, s52
    buffer_load_dwordx4 v[208:211], v2, s[28:31], s54 offen offset:0 sc1
    s_waitcnt lgkmcnt(7)
    v_mfma_f32_32x32x16_bf16 v[80:95], v[36:39], v[176:179], v[80:95]
    ds_read_b64_tr_b16 v[52:53], v23 offset:2048
    ds_read_b64_tr_b16 v[54:55], v23 offset:3072
    ds_read_b128 v[8:11], v29 offset:416
    s_waitcnt lgkmcnt(7)
    v_mfma_f32_32x32x16_bf16 v[96:111], v[40:43], v[176:179], v[96:111]
    ds_read_b64_tr_b16 v[56:57], v24 offset:2048
    ds_read_b64_tr_b16 v[58:59], v24 offset:3072
    s_cbranch_vccnz Lu_62
    v_mfma_f32_16x16x32_bf16 v[12:15], v[32:35], v[4:7], v[12:15]
Lu_62:
    s_waitcnt lgkmcnt(7)
    v_mfma_f32_32x32x16_bf16 v[112:127], v[44:47], v[176:179], v[112:127]
    ds_read_b64_tr_b16 v[60:61], v25 offset:2048
    ds_read_b64_tr_b16 v[62:63], v25 offset:3072
    s_add_u32 m0, s86, 65536
    s_add_u32 s50, s49, 16384
    buffer_load_dwordx4 v3, s[32:35], s50 offen lds
    s_waitcnt vmcnt(15) lgkmcnt(7)
    v_mfma_f32_32x32x16_bf16 v[64:79], v[48:51], v[180:183], v[64:79]
    ds_read_b64_tr_b16 v[32:33], v22 offset:4096
    ds_read_b64_tr_b16 v[34:35], v22 offset:5120
    buffer_load_dwordx4 v[212:215], v2, s[28:31], s54 offen offset:1024 sc1
    s_waitcnt lgkmcnt(7)
    v_mfma_f32_32x32x16_bf16 v[80:95], v[52:55], v[180:183], v[80:95]
    ds_read_b64_tr_b16 v[36:37], v23 offset:4096
    ds_read_b64_tr_b16 v[38:39], v23 offset:5120
    ds_read_b128 v[4:7], v29 offset:448
    s_waitcnt lgkmcnt(7)
    v_mfma_f32_32x32x16_bf16 v[96:111], v[56:59], v[180:183], v[96:111]
    ds_read_b64_tr_b16 v[40:41], v24 offset:4096
    ds_read_b64_tr_b16 v[42:43], v24 offset:5120
    s_cbranch_vccnz Lu_63
    v_mfma_f32_16x16x32_bf16 v[12:15], v[48:51], v[8:11], v[12:15]
Lu_63:
    s_waitcnt lgkmcnt(7)
    v_mfma_f32_32x32x16_bf16 v[112:127], v[60:63], v[180:183], v[112:127]
    ds_read_b64_tr_b16 v[44:45], v25 offset:4096
    ds_read_b64_tr_b16 v[46:47], v25 offset:5120
    s_add_u32 m0, s86, 73728
    s_add_u32 s50, s49, 32768
    buffer_load_dwordx4 v3, s[32:35], s50 offen lds
    s_waitcnt vmcnt(14) lgkmcnt(7)
    v_mfma_f32_32x32x16_bf16 v[64:79], v[32:35], v[184:187], v[64:79]
    ds_read_b64_tr_b16 v[48:49], v22 offset:6144
    ds_read_b64_tr_b16 v[50:51], v22 offset:7168
    buffer_load_dwordx4 v[216:219], v2, s[28:31], s54 offen offset:2048 sc1
    s_waitcnt lgkmcnt(7)
    v_mfma_f32_32x32x16_bf16 v[80:95], v[36:39], v[184:187], v[80:95]
    ds_read_b64_tr_b16 v[52:53], v23 offset:6144
    ds_read_b64_tr_b16 v[54:55], v23 offset:7168
    ds_read_b128 v[8:11], v29 offset:480
    s_waitcnt lgkmcnt(7)
    v_mfma_f32_32x32x16_bf16 v[96:111], v[40:43], v[184:187], v[96:111]
    ds_read_b64_tr_b16 v[56:57], v24 offset:6144
    ds_read_b64_tr_b16 v[58:59], v24 offset:7168
    s_cbranch_vccnz Lu_64
    v_mfma_f32_16x16x32_bf16 v[12:15], v[32:35], v[4:7], v[12:15]
Lu_64:
    s_waitcnt lgkmcnt(7)
    v_mfma_f32_32x32x16_bf16 v[112:127], v[44:47], v[184:187], v[112:127]
    ds_read_b64_tr_b16 v[60:61], v25 offset:6144
    ds_read_b64_tr_b16 v[62:63], v25 offset:7168
    s_add_u32 m0, s86, 81920
    s_add_u32 s50, s49, 49152
    buffer_load_dwordx4 v3, s[32:35], s50 offen lds
    s_waitcnt lgkmcnt(0)
    v_add_u32 v22, 0x4000, v22
    v_add_u32 v23, 0x4000, v23
    v_add_u32 v24, 0x4000, v24
    v_add_u32 v25, 0x4000, v25
    s_barrier
    s_waitcnt vmcnt(15)
    v_mfma_f32_32x32x16_bf16 v[64:79], v[48:51], v[188:191], v[64:79]
    ds_read_b64_tr_b16 v[32:33], v22 offset:0
    ds_read_b64_tr_b16 v[34:35], v22 offset:1024
    buffer_load_dwordx4 v[220:223], v2, s[28:31], s54 offen offset:3072 sc1
    v_mfma_f32_32x32x16_bf16 v[80:95], v[52:55], v[188:191], v[80:95]
    ds_read_b64_tr_b16 v[36:37], v23 offset:0
    ds_read_b64_tr_b16 v[38:39], v23 offset:1024
    ds_read_b128 v[4:7], v29 offset:512
    v_mfma_f32_32x32x16_bf16 v[96:111], v[56:59], v[188:191], v[96:111]
    ds_read_b64_tr_b16 v[40:41], v24 offset:0
    ds_read_b64_tr_b16 v[42:43], v24 offset:1024
    s_cbranch_vccnz Lu_65
    v_mfma_f32_16x16x32_bf16 v[12:15], v[48:51], v[8:11], v[12:15]
Lu_65:
    v_mfma_f32_32x32x16_bf16 v[112:127], v[60:63], v[188:191], v[112:127]
    ds_read_b64_tr_b16 v[44:45], v25 offset:0
    ds_read_b64_tr_b16 v[46:47], v25 offset:1024
    s_add_u32 s49, s25, 2
    s_cmp_ge_u32 s49, 7
    s_cselect_b32 s87, 7, 0
    s_sub_u32 s49, s49, s87
    s_lshl_b32 s49, s49, 16
    s_add_u32 s49, s49, s48
    s_add_u32 m0, s86, 90112
    s_add_u32 s50, s49, 0
    buffer_load_dwordx4 v3, s[32:35], s50 offen lds
    s_waitcnt vmcnt(15) lgkmcnt(7)
    v_mfma_f32_32x32x16_bf16 v[64:79], v[32:35], v[192:195], v[64:79]
    ds_read_b64_tr_b16 v[48:49], v22 offset:2048
    ds_read_b64_tr_b16 v[50:51], v22 offset:3072
    s_add_u32 s54, s100, 6
    s_and_b32 s54, s54, 7
    s_lshl_b32 s54, s54, 12
    s_add_u32 s54, s54, s52
    buffer_load_dwordx4 v[224:227], v2, s[28:31], s54 offen offset:0 sc1
    s_waitcnt lgkmcnt(7)
    v_mfma_f32_32x32x16_bf16 v[80:95], v[36:39], v[192:195], v[80:95]
    ds_read_b64_tr_b16 v[52:53], v23 offset:2048
    ds_read_b64_tr_b16 v[54:55], v23 offset:3072
    ds_read_b128 v[8:11], v29 offset:544
    s_waitcnt lgkmcnt(7)
    v_mfma_f32_32x32x16_bf16 v[96:111], v[40:43], v[192:195], v[96:111]
    ds_read_b64_tr_b16 v[56:57], v24 offset:2048
    ds_read_b64_tr_b16 v[58:59], v24 offset:3072
    s_cbranch_vccnz Lu_66
    v_mfma_f32_16x16x32_bf16 v[12:15], v[32:35], v[4:7], v[12:15]
Lu_66:
    s_waitcnt lgkmcnt(7)
    v_mfma_f32_32x32x16_bf16 v[112:127], v[44:47], v[192:195], v[112:127]
    ds_read_b64_tr_b16 v[60:61], v25 offset:2048
    ds_read_b64_tr_b16 v[62:63], v25 offset:3072
    s_add_u32 m0, s86, 98304
    s_add_u32 s50, s49, 16384
    buffer_load_dwordx4 v3, s[32:35], s50 offen lds
    s_waitcnt vmcnt(15) lgkmcnt(7)
    v_mfma_f32_32x32x16_bf16 v[64:79], v[48:51], v[196:199], v[64:79]
    ds_read_b64_tr_b16 v[32:33], v22 offset:4096
    ds_read_b64_tr_b16 v[34:35], v22 offset:5120
    buffer_load_dwordx4 v[228:231], v2, s[28:31], s54 offen offset:1024 sc1
    s_waitcnt lgkmcnt(7)
    v_mfma_f32_32x32x16_bf16 v[80:95], v[52:55], v[196:199], v[80:95]
    ds_read_b64_tr_b16 v[36:37], v23 offset:4096
    ds_read_b64_tr_b16 v[38:39], v23 offset:5120
    ds_read_b128 v[4:7], v29 offset:576
    s_waitcnt lgkmcnt(7)
    v_mfma_f32_32x32x16_bf16 v[96:111], v[56:59], v[196:199], v[96:111]
    ds_read_b64_tr_b16 v[40:41], v24 offset:4096
    ds_read_b64_tr_b16 v[42:43], v24 offset:5120
    s_cbranch_vccnz Lu_67
    v_mfma_f32_16x16x32_bf16 v[12:15], v[48:51], v[8:11], v[12:15]
Lu_67:
    s_waitcnt lgkmcnt(7)
    v_mfma_f32_32x32x16_bf16 v[112:127], v[60:63], v[196:199], v[112:127]
    ds_read_b64_tr_b16 v[44:45], v25 offset:4096
    ds_read_b64_tr_b16 v[46:47], v25 offset:5120
    s_add_u32 m0, s86, 106496
    s_add_u32 s50, s49, 32768
    buffer_load_dwordx4 v3, s[32:35], s50 offen lds
    s_waitcnt vmcnt(15) lgkmcnt(7)
    v_mfma_f32_32x32x16_bf16 v[64:79], v[32:35], v[200:203], v[64:79]
    ds_read_b64_tr_b16 v[48:49], v22 offset:6144
    ds_read_b64_tr_b16 v[50:51], v22 offset:7168
    buffer_load_dwordx4 v[232:235], v2, s[28:31], s54 offen offset:2048 sc1
    s_waitcnt lgkmcnt(7)
    v_mfma_f32_32x32x16_bf16 v[80:95], v[36:39], v[200:203], v[80:95]
    ds_read_b64_tr_b16 v[52:53], v23 offset:6144
    ds_read_b64_tr_b16 v[54:55], v23 offset:7168
    ds_read_b128 v[8:11], v29 offset:608
    s_waitcnt lgkmcnt(7)
    v_mfma_f32_32x32x16_bf16 v[96:111], v[40:43], v[200:203], v[96:111]
    ds_read_b64_tr_b16 v[56:57], v24 offset:6144
    ds_read_b64_tr_b16 v[58:59], v24 offset:7168
    s_cbranch_vccnz Lu_68
    v_mfma_f32_16x16x32_bf16 v[12:15], v[32:35], v[4:7], v[12:15]
Lu_68:
    s_waitcnt lgkmcnt(7)
    v_mfma_f32_32x32x16_bf16 v[112:127], v[44:47], v[200:203], v[112:127]
    ds_read_b64_tr_b16 v[60:61], v25 offset:6144
    ds_read_b64_tr_b16 v[62:63], v25 offset:7168
    s_waitcnt lgkmcnt(0)
    v_add_u32 v22, 0xfffe4000, v22
    v_add_u32 v23, 0xfffe4000, v23
    v_add_u32 v24, 0xfffe4000, v24
    v_add_u32 v25, 0xfffe4000, v25
    s_barrier
    s_waitcnt vmcnt(14)
    v_mfma_f32_32x32x16_bf16 v[64:79], v[48:51], v[204:207], v[64:79]
    ds_read_b64_tr_b16 v[32:33], v22 offset:0
    ds_read_b64_tr_b16 v[34:35], v22 offset:1024
    buffer_load_dwordx4 v[236:239], v2, s[28:31], s54 offen offset:3072 sc1
    v_mfma_f32_32x32x16_bf16 v[80:95], v[52:55], v[204:207], v[80:95]
    ds_read_b64_tr_b16 v[36:37], v23 offset:0
    ds_read_b64_tr_b16 v[38:39], v23 offset:1024
    ds_read_b128 v[4:7], v29 offset:640
    v_mfma_f32_32x32x16_bf16 v[96:111], v[56:59], v[204:207], v[96:111]
    ds_read_b64_tr_b16 v[40:41], v24 offset:0
    ds_read_b64_tr_b16 v[42:43], v24 offset:1024
    s_cbranch_vccnz Lu_69
    v_mfma_f32_16x16x32_bf16 v[12:15], v[48:51], v[8:11], v[12:15]
Lu_69:
    v_mfma_f32_32x32x16_bf16 v[112:127], v[60:63], v[204:207], v[112:127]
    ds_read_b64_tr_b16 v[44:45], v25 offset:0
    ds_read_b64_tr_b16 v[46:47], v25 offset:1024
    s_add_u32 m0, s86, 114688
    s_add_u32 s50, s49, 49152
    buffer_load_dwordx4 v3, s[32:35], s50 offen lds
    s_waitcnt vmcnt(14) lgkmcnt(7)
    v_mfma_f32_32x32x16_bf16 v[64:79], v[32:35], v[208:211], v[64:79]
    ds_read_b64_tr_b16 v[48:49], v22 offset:2048
    ds_read_b64_tr_b16 v[50:51], v22 offset:3072
    s_add_u32 s54, s100, 7
    s_and_b32 s54, s54, 7
    s_lshl_b32 s54, s54, 12
    s_add_u32 s54, s54, s52
    buffer_load_dwordx4 v[240:243], v2, s[28:31], s54 offen offset:0 sc1
    s_waitcnt lgkmcnt(7)
    v_mfma_f32_32x32x16_bf16 v[80:95], v[36:39], v[208:211], v[80:95]
    ds_read_b64_tr_b16 v[52:53], v23 offset:2048
    ds_read_b64_tr_b16 v[54:55], v23 offset:3072
    ds_read_b128 v[8:11], v29 offset:672
    s_waitcnt lgkmcnt(7)
    v_mfma_f32_32x32x16_bf16 v[96:111], v[40:43], v[208:211], v[96:111]
    ds_read_b64_tr_b16 v[56:57], v24 offset:2048
    ds_read_b64_tr_b16 v[58:59], v24 offset:3072
    s_cbranch_vccnz Lu_70
    v_mfma_f32_16x16x32_bf16 v[12:15], v[32:35], v[4:7], v[12:15]
Lu_70:
    s_waitcnt lgkmcnt(7)
    v_mfma_f32_32x32x16_bf16 v[112:127], v[44:47], v[208:211], v[112:127]
    ds_read_b64_tr_b16 v[60:61], v25 offset:2048
    ds_read_b64_tr_b16 v[62:63], v25 offset:3072
    s_add_u32 s49, s25, 3
    s_cmp_ge_u32 s49, 7
    s_cselect_b32 s87, 7, 0
    s_sub_u32 s49, s49, s87
    s_lshl_b32 s49, s49, 16
    s_add_u32 s49, s49, s48
    s_add_u32 m0, s86, 122880
    s_add_u32 s50, s49, 0
    buffer_load_dwordx4 v3, s[32:35], s50 offen lds
    s_waitcnt vmcnt(14) lgkmcnt(7)
    v_mfma_f32_32x32x16_bf16 v[64:79], v[48:51], v[212:215], v[64:79]
    ds_read_b64_tr_b16 v[32:33], v22 offset:4096
    ds_read_b64_tr_b16 v[34:35], v22 offset:5120
    buffer_load_dwordx4 v[244:247], v2, s[28:31], s54 offen offset:1024 sc1
    s_waitcnt lgkmcnt(7)
    v_mfma_f32_32x32x16_bf16 v[80:95], v[52:55], v[212:215], v[80:95]
    ds_read_b64_tr_b16 v[36:37], v23 offset:4096
    ds_read_b64_tr_b16 v[38:39], v23 offset:5120
    ds_read_b128 v[4:7], v29 offset:704
    s_waitcnt lgkmcnt(7)
    v_mfma_f32_32x32x16_bf16 v[96:111], v[56:59], v[212:215], v[96:111]
    ds_read_b64_tr_b16 v[40:41], v24 offset:4096
    ds_read_b64_tr_b16 v[42:43], v24 offset:5120
    s_cbranch_vccnz Lu_71
    v_mfma_f32_16x16x32_bf16 v[12:15], v[48:51], v[8:11], v[12:15]
Lu_71:
    s_waitcnt lgkmcnt(7)
    v_mfma_f32_32x32x16_bf16 v[112:127], v[60:63], v[212:215], v[112:127]
    ds_read_b64_tr_b16 v[44:45], v25 offset:4096
    ds_read_b64_tr_b16 v[46:47], v25 offset:5120
    s_waitcnt vmcnt(13) lgkmcnt(7)
    v_mfma_f32_32x32x16_bf16 v[64:79], v[32:35], v[216:219], v[64:79]
    ds_read_b64_tr_b16 v[48:49], v22 offset:6144
    ds_read_b64_tr_b16 v[50:51], v22 offset:7168
    buffer_load_dwordx4 v[248:251], v2, s[28:31], s54 offen offset:2048 sc1
    s_waitcnt lgkmcnt(7)
    v_mfma_f32_32x32x16_bf16 v[80:95], v[36:39], v[216:219], v[80:95]
    ds_read_b64_tr_b16 v[52:53], v23 offset:6144
    ds_read_b64_tr_b16 v[54:55], v23 offset:7168
    ds_read_b128 v[8:11], v29 offset:736
    s_waitcnt lgkmcnt(7)
    v_mfma_f32_32x32x16_bf16 v[96:111], v[40:43], v[216:219], v[96:111]
    ds_read_b64_tr_b16 v[56:57], v24 offset:6144
    ds_read_b64_tr_b16 v[58:59], v24 offset:7168
    s_cbranch_vccnz Lu_72
    v_mfma_f32_16x16x32_bf16 v[12:15], v[32:35], v[4:7], v[12:15]
Lu_72:
    s_waitcnt lgkmcnt(7)
    v_mfma_f32_32x32x16_bf16 v[112:127], v[44:47], v[216:219], v[112:127]
    ds_read_b64_tr_b16 v[60:61], v25 offset:6144
    ds_read_b64_tr_b16 v[62:63], v25 offset:7168
    s_waitcnt vmcnt(2) lgkmcnt(0)
    v_add_u32 v22, 0x4000, v22
    v_add_u32 v23, 0x4000, v23
    v_add_u32 v24, 0x4000, v24
    v_add_u32 v25, 0x4000, v25
    s_barrier
    v_mfma_f32_32x32x16_bf16 v[64:79], v[48:51], v[220:223], v[64:79]
    ds_read_b64_tr_b16 v[32:33], v22 offset:0
    ds_read_b64_tr_b16 v[34:35], v22 offset:1024
    buffer_load_dwordx4 v[252:255], v2, s[28:31], s54 offen offset:3072 sc1
    v_mfma_f32_32x32x16_bf16 v[80:95], v[52:55], v[220:223], v[80:95]
    ds_read_b64_tr_b16 v[36:37], v23 offset:0
    ds_read_b64_tr_b16 v[38:39], v23 offset:1024
    ds_read_b128 v[4:7], v29 offset:768
    v_mfma_f32_32x32x16_bf16 v[96:111], v[56:59], v[220:223], v[96:111]
    ds_read_b64_tr_b16 v[40:41], v24 offset:0
    ds_read_b64_tr_b16 v[42:43], v24 offset:1024
    s_cbranch_vccnz Lu_73
    v_mfma_f32_16x16x32_bf16 v[12:15], v[48:51], v[8:11], v[12:15]
Lu_73:
    v_mfma_f32_32x32x16_bf16 v[112:127], v[60:63], v[220:223], v[112:127]
    ds_read_b64_tr_b16 v[44:45], v25 offset:0
    ds_read_b64_tr_b16 v[46:47], v25 offset:1024
    s_add_u32 m0, s86, 0
    s_add_u32 s50, s49, 16384
    buffer_load_dwordx4 v3, s[32:35], s50 offen lds
    ds_read_b64_tr_b16 v[128:129], v26 offset:0
    ds_read_b64_tr_b16 v[130:131], v26 offset:1024
    ds_read_b64_tr_b16 v[132:133], v27 offset:0
    ds_read_b64_tr_b16 v[134:135], v27 offset:1024
    ds_read_b64_tr_b16 v[136:137], v26 offset:8192
    ds_read_b64_tr_b16 v[138:139], v26 offset:9216
    ds_read_b64_tr_b16 v[140:141], v27 offset:8192
    ds_read_b64_tr_b16 v[142:143], v27 offset:9216
    s_waitcnt lgkmcnt(15)
    v_mfma_f32_32x32x16_bf16 v[64:79], v[32:35], v[224:227], v[64:79]
    ds_read_b64_tr_b16 v[48:49], v22 offset:2048
    ds_read_b64_tr_b16 v[50:51], v22 offset:3072
    s_waitcnt lgkmcnt(15)
    v_mfma_f32_32x32x16_bf16 v[80:95], v[36:39], v[224:227], v[80:95]
    ds_read_b64_tr_b16 v[52:53], v23 offset:2048
    ds_read_b64_tr_b16 v[54:55], v23 offset:3072
    ds_read_b128 v[8:11], v29 offset:800
    s_waitcnt lgkmcnt(15)
    v_mfma_f32_32x32x16_bf16 v[96:111], v[40:43], v[224:227], v[96:111]
    ds_read_b64_tr_b16 v[56:57], v24 offset:2048
    ds_read_b64_tr_b16 v[58:59], v24 offset:3072
    s_cbranch_vccnz Lu_74
    v_mfma_f32_16x16x32_bf16 v[12:15], v[32:35], v[4:7], v[12:15]
Lu_74:
    s_waitcnt lgkmcnt(15)
    v_mfma_f32_32x32x16_bf16 v[112:127], v[44:47], v[224:227], v[112:127]
    ds_read_b64_tr_b16 v[60:61], v25 offset:2048
    ds_read_b64_tr_b16 v[62:63], v25 offset:3072
    s_lshl_b32 s55, s26, 13
    s_add_u32 s55, s55, s97
    s_add_u32 s55, s55, 65536
    s_add_u32 s56, s55, 4096
    buffer_load_dwordx4 v[192:195], v2, s[28:31], s55 offen offset:0 sc1
    buffer_load_dwordx4 v[196:199], v2, s[28:31], s55 offen offset:1024 sc1
    buffer_load_dwordx4 v[200:203], v2, s[28:31], s55 offen offset:2048 sc1
    buffer_load_dwordx4 v[204:207], v2, s[28:31], s55 offen offset:3072 sc1
    buffer_load_dwordx4 v[208:211], v2, s[28:31], s56 offen offset:0 sc1
    buffer_load_dwordx4 v[212:215], v2, s[28:31], s56 offen offset:1024 sc1
    buffer_load_dwordx4 v[216:219], v2, s[28:31], s56 offen offset:2048 sc1
    buffer_load_dwordx4 v[220:223], v2, s[28:31], s56 offen offset:3072 sc1
    s_add_u32 m0, s86, 8192
    s_add_u32 s50, s49, 32768
    buffer_load_dwordx4 v3, s[32:35], s50 offen lds
    ds_read_b64_tr_b16 v[144:145], v26 offset:16384
    ds_read_b64_tr_b16 v[146:147], v26 offset:17408
    ds_read_b64_tr_b16 v[148:149], v27 offset:16384
    ds_read_b64_tr_b16 v[150:151], v27 offset:17408
    ds_read_b64_tr_b16 v[152:153], v26 offset:24576
    ds_read_b64_tr_b16 v[154:155], v26 offset:25600
    ds_read_b64_tr_b16 v[156:157], v27 offset:24576
    ds_read_b64_tr_b16 v[158:159], v27 offset:25600
    s_waitcnt lgkmcnt(15)
    v_mfma_f32_32x32x16_bf16 v[64:79], v[48:51], v[228:231], v[64:79]
    ds_read_b64_tr_b16 v[32:33], v22 offset:4096
    ds_read_b64_tr_b16 v[34:35], v22 offset:5120
    s_waitcnt lgkmcnt(15)
    v_mfma_f32_32x32x16_bf16 v[80:95], v[52:55], v[228:231], v[80:95]
    ds_read_b64_tr_b16 v[36:37], v23 offset:4096
    ds_read_b64_tr_b16 v[38:39], v23 offset:5120
    ds_read_b128 v[4:7], v29 offset:832
    s_waitcnt lgkmcnt(15)
    v_mfma_f32_32x32x16_bf16 v[96:111], v[56:59], v[228:231], v[96:111]
    ds_read_b64_tr_b16 v[40:41], v24 offset:4096
    ds_read_b64_tr_b16 v[42:43], v24 offset:5120
    s_cbranch_vccnz Lu_75
    v_mfma_f32_16x16x32_bf16 v[12:15], v[48:51], v[8:11], v[12:15]
Lu_75:
    s_waitcnt lgkmcnt(15)
    v_mfma_f32_32x32x16_bf16 v[112:127], v[60:63], v[228:231], v[112:127]
    ds_read_b64_tr_b16 v[44:45], v25 offset:4096
    ds_read_b64_tr_b16 v[46:47], v25 offset:5120
    ds_read_b64_tr_b16 v[160:161], v26 offset:32768
    ds_read_b64_tr_b16 v[162:163], v26 offset:33792
    ds_read_b64_tr_b16 v[164:165], v27 offset:32768
    ds_read_b64_tr_b16 v[166:167], v27 offset:33792
    ds_read_b64_tr_b16 v[168:169], v26 offset:40960
    ds_read_b64_tr_b16 v[170:171], v26 offset:41984
    ds_read_b64_tr_b16 v[172:173], v27 offset:40960
    ds_read_b64_tr_b16 v[174:175], v27 offset:41984
    s_waitcnt lgkmcnt(15)
    v_mfma_f32_32x32x16_bf16 v[64:79], v[32:35], v[232:235], v[64:79]
    ds_read_b64_tr_b16 v[48:49], v22 offset:6144
    ds_read_b64_tr_b16 v[50:51], v22 offset:7168
    s_waitcnt lgkmcnt(15)
    v_mfma_f32_32x32x16_bf16 v[80:95], v[36:39], v[232:235], v[80:95]
    ds_read_b64_tr_b16 v[52:53], v23 offset:6144
    ds_read_b64_tr_b16 v[54:55], v23 offset:7168
    ds_read_b128 v[8:11], v29 offset:864
    s_waitcnt lgkmcnt(15)
    v_mfma_f32_32x32x16_bf16 v[96:111], v[40:43], v[232:235], v[96:111]
    ds_read_b64_tr_b16 v[56:57], v24 offset:6144
    ds_read_b64_tr_b16 v[58:59], v24 offset:7168
    s_cbranch_vccnz Lu_76
    v_mfma_f32_16x16x32_bf16 v[12:15], v[32:35], v[4:7], v[12:15]
Lu_76:
    s_waitcnt lgkmcnt(15)
    v_mfma_f32_32x32x16_bf16 v[112:127], v[44:47], v[232:235], v[112:127]
    ds_read_b64_tr_b16 v[60:61], v25 offset:6144
    ds_read_b64_tr_b16 v[62:63], v25 offset:7168
    ds_read_b64_tr_b16 v[176:177], v26 offset:49152
    ds_read_b64_tr_b16 v[178:179], v26 offset:50176
    ds_read_b64_tr_b16 v[180:181], v27 offset:49152
    ds_read_b64_tr_b16 v[182:183], v27 offset:50176
    ds_read_b64_tr_b16 v[184:185], v26 offset:57344
    ds_read_b64_tr_b16 v[186:187], v26 offset:58368
    ds_read_b64_tr_b16 v[188:189], v27 offset:57344
    ds_read_b64_tr_b16 v[190:191], v27 offset:58368
    s_waitcnt lgkmcnt(0)
    v_add_u32 v22, 0x4000, v22
    v_add_u32 v23, 0x4000, v23
    v_add_u32 v24, 0x4000, v24
    v_add_u32 v25, 0x4000, v25
    s_barrier
    v_mfma_f32_32x32x16_bf16 v[64:79], v[48:51], v[236:239], v[64:79]
    ds_read_b64_tr_b16 v[32:33], v22 offset:0
    ds_read_b64_tr_b16 v[34:35], v22 offset:1024
    v_mfma_f32_32x32x16_bf16 v[80:95], v[52:55], v[236:239], v[80:95]
    ds_read_b64_tr_b16 v[36:37], v23 offset:0
    ds_read_b64_tr_b16 v[38:39], v23 offset:1024
    ds_read_b128 v[4:7], v29 offset:896
    v_mfma_f32_32x32x16_bf16 v[96:111], v[56:59], v[236:239], v[96:111]
    ds_read_b64_tr_b16 v[40:41], v24 offset:0
    ds_read_b64_tr_b16 v[42:43], v24 offset:1024
    s_cbranch_vccnz Lu_77
    v_mfma_f32_16x16x32_bf16 v[12:15], v[48:51], v[8:11], v[12:15]
Lu_77:
    v_mfma_f32_32x32x16_bf16 v[112:127], v[60:63], v[236:239], v[112:127]
    ds_read_b64_tr_b16 v[44:45], v25 offset:0
    ds_read_b64_tr_b16 v[46:47], v25 offset:1024
    s_add_u32 m0, s86, 16384
    s_add_u32 s50, s49, 49152
    buffer_load_dwordx4 v3, s[32:35], s50 offen lds
    s_add_u32 s49, s25, 4
    s_cmp_ge_u32 s49, 7
    s_cselect_b32 s87, 7, 0
    s_sub_u32 s49, s49, s87
    s_lshl_b32 s49, s49, 16
    s_add_u32 s49, s49, s48
    s_add_u32 m0, s86, 65536
    s_add_u32 s50, s49, 49152
    buffer_load_dwordx4 v3, s[32:35], s50 offen lds
    s_add_u32 s49, s25, 5
    s_cmp_ge_u32 s49, 7
    s_cselect_b32 s87, 7, 0
    s_sub_u32 s49, s49, s87
    s_lshl_b32 s49, s49, 16
    s_add_u32 s49, s49, s48
    s_add_u32 m0, s86, 73728
    s_add_u32 s50, s49, 0
    buffer_load_dwordx4 v3, s[32:35], s50 offen lds
    s_waitcnt lgkmcnt(7)
    v_mfma_f32_32x32x16_bf16 v[64:79], v[32:35], v[240:243], v[64:79]
    ds_read_b64_tr_b16 v[48:49], v22 offset:2048
    ds_read_b64_tr_b16 v[50:51], v22 offset:3072
    s_waitcnt vmcnt(4)
    v_add_f32 v192, v192, v208
    v_add_f32 v193, v193, v209
    v_add_f32 v194, v194, v210
    v_add_f32 v195, v195, v211
    v_add_f32 v196, v196, v212
    s_waitcnt lgkmcnt(7)
    v_mfma_f32_32x32x16_bf16 v[80:95], v[36:39], v[240:243], v[80:95]
    ds_read_b64_tr_b16 v[52:53], v23 offset:2048
    ds_read_b64_tr_b16 v[54:55], v23 offset:3072
    ds_read_b128 v[8:11], v29 offset:928
    v_add_f32 v197, v197, v213
    v_add_f32 v198, v198, v214
    v_add_f32 v199, v199, v215
    v_add_f32 v200, v200, v216
    v_add_f32 v201, v201, v217
    v_add_f32 v202, v202, v218
    s_waitcnt lgkmcnt(7)
    v_mfma_f32_32x32x16_bf16 v[96:111], v[40:43], v[240:243], v[96:111]
    ds_read_b64_tr_b16 v[56:57], v24 offset:2048
    ds_read_b64_tr_b16 v[58:59], v24 offset:3072
    s_cbranch_vccnz Lu_78
    v_mfma_f32_16x16x32_bf16 v[12:15], v[32:35], v[4:7], v[12:15]
Lu_78:
    v_add_f32 v203, v203, v219
    v_add_f32 v204, v204, v220
    v_add_f32 v205, v205, v221
    v_add_f32 v206, v206, v222
    v_add_f32 v207, v207, v223
    v_add_f32 v192, v192, v200
    s_waitcnt lgkmcnt(7)
    v_mfma_f32_32x32x16_bf16 v[112:127], v[44:47], v[240:243], v[112:127]
    ds_read_b64_tr_b16 v[60:61], v25 offset:2048
    ds_read_b64_tr_b16 v[62:63], v25 offset:3072
    s_add_u32 s49, s25, 4
    s_cmp_ge_u32 s49, 7
    s_cselect_b32 s87, 7, 0
    s_sub_u32 s49, s49, s87
    s_lshl_b32 s49, s49, 16
    s_add_u32 s49, s49, s48
    s_add_u32 m0, s86, 24576
    s_add_u32 s50, s49, 0
    buffer_load_dwordx4 v3, s[32:35], s50 offen lds
    s_add_u32 s49, s25, 5
    s_cmp_ge_u32 s49, 7
    s_cselect_b32 s87, 7, 0
    s_sub_u32 s49, s49, s87
    s_lshl_b32 s49, s49, 16
    s_add_u32 s49, s49, s48
    s_add_u32 m0, s86, 81920
    s_add_u32 s50, s49, 16384
    buffer_load_dwordx4 v3, s[32:35], s50 offen lds
    s_add_u32 m0, s86, 90112
    s_add_u32 s50, s49, 32768
    buffer_load_dwordx4 v3, s[32:35], s50 offen lds
    v_add_f32 v193, v193, v201
    v_add_f32 v194, v194, v202
    v_add_f32 v195, v195, v203
    v_add_f32 v196, v196, v204
    v_add_f32 v197, v197, v205
    v_add_f32 v198, v198, v206
    s_waitcnt lgkmcnt(7)
    v_mfma_f32_32x32x16_bf16 v[64:79], v[48:51], v[244:247], v[64:79]
    ds_read_b64_tr_b16 v[32:33], v22 offset:4096
    ds_read_b64_tr_b16 v[34:35], v22 offset:5120
    v_add_f32 v199, v199, v207
    v_add_f32 v192, v192, v196
    v_add_f32 v193, v193, v197
    v_add_f32 v194, v194, v198
    v_add_f32 v195, v195, v199
    s_waitcnt lgkmcnt(7)
    v_mfma_f32_32x32x16_bf16 v[80:95], v[52:55], v[244:247], v[80:95]
    ds_read_b64_tr_b16 v[36:37], v23 offset:4096
    ds_read_b64_tr_b16 v[38:39], v23 offset:5120
    ds_read_b128 v[4:7], v29 offset:960
    v_add_f32 v192, v192, v194
    v_add_f32 v193, v193, v195
    v_mov_b32 v194, v192
    v_mov_b32 v195, v193
    v_mov_b32 v196, 0
    s_waitcnt lgkmcnt(7)
    v_mfma_f32_32x32x16_bf16 v[96:111], v[56:59], v[244:247], v[96:111]
    ds_read_b64_tr_b16 v[40:41], v24 offset:4096
    ds_read_b64_tr_b16 v[42:43], v24 offset:5120
    s_cbranch_vccnz Lu_79
    v_mfma_f32_16x16x32_bf16 v[12:15], v[48:51], v[8:11], v[12:15]
Lu_79:
    v_mov_b32 v197, 0
    v_permlane32_swap_b32 v192, v194
    v_permlane32_swap_b32 v193, v195
    v_mov_b32 v200, 0
    v_add_f32 v192, v192, v194
    s_waitcnt lgkmcnt(7)
    v_mfma_f32_32x32x16_bf16 v[112:127], v[60:63], v[244:247], v[112:127]
    ds_read_b64_tr_b16 v[44:45], v25 offset:4096
    ds_read_b64_tr_b16 v[46:47], v25 offset:5120
    s_add_u32 m0, s86, 98304
    s_add_u32 s50, s49, 49152
    buffer_load_dwordx4 v3, s[32:35], s50 offen lds
    s_add_u32 s49, s25, 6
    s_cmp_ge_u32 s49, 7
    s_cselect_b32 s87, 7, 0
    s_sub_u32 s49, s49, s87
    s_lshl_b32 s49, s49, 16
    s_add_u32 s49, s49, s48
    s_add_u32 m0, s86, 106496
    s_add_u32 s50, s49, 0
    buffer_load_dwordx4 v3, s[32:35], s50 offen lds
    v_add_f32 v193, v193, v195
    v_mul_f32 v192, 0x3b000000, v192
    v_mul_f32 v193, 0x3b000000, v193
    v_fma_f32 v193, -v192, v192, v193
    v_max_f32 v193, 0, v193
    s_waitcnt lgkmcnt(7)
    v_mfma_f32_32x32x16_bf16 v[64:79], v[32:35], v[248:251], v[64:79]
    ds_read_b64_tr_b16 v[48:49], v22 offset:6144
    ds_read_b64_tr_b16 v[50:51], v22 offset:7168
    v_cvt_pk_bf16_f32 v193, v193, v193
    v_lshlrev_b32 v193, 16, v193
    v_add_f32 v193, 0x3727c5ac, v193
    v_cvt_pk_bf16_f32 v193, v193, v193
    v_lshlrev_b32 v193, 16, v193
    s_waitcnt lgkmcnt(7)
    v_mfma_f32_32x32x16_bf16 v[80:95], v[36:39], v[248:251], v[80:95]
    ds_read_b64_tr_b16 v[52:53], v23 offset:6144
    ds_read_b64_tr_b16 v[54:55], v23 offset:7168
    ds_read_b128 v[8:11], v29 offset:992
    v_sqrt_f32 v193, v193
    v_cvt_pk_bf16_f32 v192, -v192, -v192
    v_mov_b32 v201, 0
    v_cvt_pk_bf16_f32 v193, v193, v193
    s_mov_b32 s60, -1
    s_mov_b32 s61, 0
    s_waitcnt lgkmcnt(7)
    v_mfma_f32_32x32x16_bf16 v[96:111], v[40:43], v[248:251], v[96:111]
    ds_read_b64_tr_b16 v[56:57], v24 offset:6144
    ds_read_b64_tr_b16 v[58:59], v24 offset:7168
    s_cbranch_vccnz Lu_80
    v_mfma_f32_16x16x32_bf16 v[12:15], v[32:35], v[4:7], v[12:15]
Lu_80:
    v_mov_b32 v204, 0
    v_mov_b32 v205, 0
    v_cndmask_b32_e64 v198, 0, v192, s[60:61]
    v_cndmask_b32_e64 v202, v192, 0, s[60:61]
    v_cndmask_b32_e64 v199, 0, v193, s[60:61]
    s_waitcnt lgkmcnt(7)
    v_mfma_f32_32x32x16_bf16 v[112:127], v[44:47], v[248:251], v[112:127]
    ds_read_b64_tr_b16 v[60:61], v25 offset:6144
    ds_read_b64_tr_b16 v[62:63], v25 offset:7168
    s_add_u32 m0, s86, 114688
    s_add_u32 s50, s49, 16384
    buffer_load_dwordx4 v3, s[32:35], s50 offen lds
    s_add_u32 m0, s86, 122880
    s_add_u32 s50, s49, 32768
    buffer_load_dwordx4 v3, s[32:35], s50 offen lds
    v_cndmask_b32_e64 v203, v193, 0, s[60:61]
    v_lshlrev_b32 v193, 16, v193
    v_rcp_f32 v192, v193
    v_and_b32 v30, 1, v1
    v_lshlrev_b32 v30, 9, v30
    s_waitcnt lgkmcnt(7)
    v_mfma_f32_32x32x16_bf16 v[64:79], v[48:51], v[252:255], v[64:79]
    v_and_b32 v31, 2, v1
    v_lshl_add_u32 v30, v31, 1, v30
    v_and_b32 v31, 48, v1
    v_lshl_add_u32 v30, v31, 3, v30
    s_lshl_b32 s55, s27, 3
    s_add_u32 s55, s55, 158720
    s_waitcnt lgkmcnt(5)
    v_mfma_f32_32x32x16_bf16 v[80:95], v[52:55], v[252:255], v[80:95]
    v_add_u32 v30, s55, v30
    v_mul_f32 v192, v192, v192
    v_and_b32 v31, 31, v1
    v_lshlrev_b32 v31, 5, v31
    v_lshl_add_u32 v31, v28, 4, v31
    s_waitcnt lgkmcnt(2)
    v_mfma_f32_32x32x16_bf16 v[96:111], v[56:59], v[252:255], v[96:111]
    s_cbranch_vccnz Lu_81
    v_mfma_f32_16x16x32_bf16 v[12:15], v[48:51], v[8:11], v[12:15]
Lu_81:
    v_xor_b32 v31, s55, v31
    v_xor_b32 v193, 8, v31
    s_lshl_b32 s56, s101, 0
    s_mul_i32 s55, s53, 28
    s_add_u32 s55, s55, s56
    s_lshl_b32 s55, s55, 2
    s_add_u32 s55, s55, s27
    s_lshl_b32 s55, s55, 10
    s_add_u32 s55, s55, 9437184
    s_waitcnt lgkmcnt(0)
    v_mfma_f32_32x32x16_bf16 v[112:127], v[60:63], v[252:255], v[112:127]
    s_cbranch_vccnz L_nuw
    v_cvt_pk_bf16_f32 v4, v12, v12
    v_cvt_pk_bf16_f32 v5, v13, v13
    v_cvt_pk_bf16_f32 v6, v14, v14
    v_cvt_pk_bf16_f32 v7, v15, v15
    v_lshlrev_b32 v4, 16, v4
    v_lshlrev_b32 v5, 16, v5
    v_lshlrev_b32 v6, 16, v6
    v_lshlrev_b32 v7, 16, v7
    v_sub_f32 v4, v12, v4
    v_sub_f32 v5, v13, v5
    v_sub_f32 v6, v14, v6
    v_sub_f32 v7, v15, v7
    v_cvt_pk_bf16_f32 v4, v12, v4
    v_cvt_pk_bf16_f32 v5, v13, v5
    v_cvt_pk_bf16_f32 v6, v14, v6
    v_cvt_pk_bf16_f32 v7, v15, v7
    s_mov_b32 exec_lo, 0x000f000f
    s_mov_b32 exec_hi, 0x000f000f
    ds_write2_b32 v30, v4, v5 offset0:0 offset1:8
    ds_write2_b32 v30, v6, v7 offset0:16 offset1:24
    s_mov_b64 exec, -1
L_nuw:
    s_waitcnt lgkmcnt(0)
    s_barrier
    ds_read_b64 v[32:33], v31
    ds_read_b64 v[34:35], v193
    s_cmp_lg_u32 s101, 0
    s_cbranch_scc1 Lo_82
    v_lshlrev_b32 v13, 2, v1
    s_lshl_b32 s56, s26, 7
    s_add_u32 s56, s56, s96
    s_mov_b32 exec_hi, 0
    buffer_store_dword v192, v13, s[28:31], s56 offen offset:1024 sc1
    s_mov_b32 exec_hi, -1
Lo_82:
    s_waitcnt lgkmcnt(0)
    v_mfma_f32_32x32x16_bf16 v[64:79], v[32:35], v[198:201], v[64:79]
    v_mfma_f32_32x32x16_bf16 v[80:95], v[32:35], v[196:199], v[80:95]
    v_mfma_f32_32x32x16_bf16 v[96:111], v[32:35], v[202:205], v[96:111]
    v_mfma_f32_32x32x16_bf16 v[112:127], v[32:35], v[200:203], v[112:127]
    s_nop 8
    v_max_f32 v64, 0, v64
    v_max_f32 v65, 0, v65
    v_max_f32 v66, 0, v66
    v_max_f32 v67, 0, v67
    v_max_f32 v68, 0, v68
    v_max_f32 v69, 0, v69
    v_max_f32 v70, 0, v70
    v_max_f32 v71, 0, v71
    v_pk_mul_f32 v[64:65], v[64:65], v[72:73]
    v_pk_mul_f32 v[66:67], v[66:67], v[74:75]
    v_pk_mul_f32 v[68:69], v[68:69], v[76:77]
    v_pk_mul_f32 v[70:71], v[70:71], v[78:79]
    v_cvt_pk_bf16_f32 v72, v64, v65
    v_cvt_pk_bf16_f32 v73, v66, v67
    v_cvt_pk_bf16_f32 v74, v68, v69
    v_cvt_pk_bf16_f32 v75, v70, v71
    s_xor_b32 s56, s55, 0
    buffer_store_dwordx4 v[72:75], v2, s[28:31], s56 offen sc1
    v_max_f32 v80, 0, v80
    v_max_f32 v81, 0, v81
    v_max_f32 v82, 0, v82
    v_max_f32 v83, 0, v83
    v_max_f32 v84, 0, v84
    v_max_f32 v85, 0, v85
    v_max_f32 v86, 0, v86
    v_max_f32 v87, 0, v87
    v_pk_mul_f32 v[80:81], v[80:81], v[88:89]
    v_pk_mul_f32 v[82:83], v[82:83], v[90:91]
    v_pk_mul_f32 v[84:85], v[84:85], v[92:93]
    v_pk_mul_f32 v[86:87], v[86:87], v[94:95]
    v_cvt_pk_bf16_f32 v88, v80, v81
    v_cvt_pk_bf16_f32 v89, v82, v83
    v_cvt_pk_bf16_f32 v90, v84, v85
    v_cvt_pk_bf16_f32 v91, v86, v87
    s_xor_b32 s56, s55, 1024
    buffer_store_dwordx4 v[88:91], v2, s[28:31], s56 offen sc1
    v_max_f32 v96, 0, v96
    v_max_f32 v97, 0, v97
    v_max_f32 v98, 0, v98
    v_max_f32 v99, 0, v99
    v_max_f32 v100, 0, v100
    v_max_f32 v101, 0, v101
    v_max_f32 v102, 0, v102
    v_max_f32 v103, 0, v103
    v_pk_mul_f32 v[96:97], v[96:97], v[104:105]
    v_pk_mul_f32 v[98:99], v[98:99], v[106:107]
    v_pk_mul_f32 v[100:101], v[100:101], v[108:109]
    v_pk_mul_f32 v[102:103], v[102:103], v[110:111]
    v_cvt_pk_bf16_f32 v104, v96, v97
    v_cvt_pk_bf16_f32 v105, v98, v99
    v_cvt_pk_bf16_f32 v106, v100, v101
    v_cvt_pk_bf16_f32 v107, v102, v103
    s_xor_b32 s56, s55, 2048
    buffer_store_dwordx4 v[104:107], v2, s[28:31], s56 offen sc1
    v_max_f32 v112, 0, v112
    v_max_f32 v113, 0, v113
    v_max_f32 v114, 0, v114
    v_max_f32 v115, 0, v115
    v_max_f32 v116, 0, v116
    v_max_f32 v117, 0, v117
    v_max_f32 v118, 0, v118
    v_max_f32 v119, 0, v119
    v_pk_mul_f32 v[112:113], v[112:113], v[120:121]
    v_pk_mul_f32 v[114:115], v[114:115], v[122:123]
    v_pk_mul_f32 v[116:117], v[116:117], v[124:125]
    v_pk_mul_f32 v[118:119], v[118:119], v[126:127]
    v_cvt_pk_bf16_f32 v120, v112, v113
    v_cvt_pk_bf16_f32 v121, v114, v115
    v_cvt_pk_bf16_f32 v122, v116, v117
    v_cvt_pk_bf16_f32 v123, v118, v119
    s_xor_b32 s56, s55, 3072
    buffer_store_dwordx4 v[120:123], v2, s[28:31], s56 offen sc1
    s_branch L_gj
L_pf:
    s_waitcnt vmcnt(0) lgkmcnt(0)
    s_barrier
    s_cmp_eq_u32 s26, 7
    s_cbranch_scc1 Lh_83
    s_branch Lj_84
Lh_83:
    v_mov_b32 v15, s99
    s_lshl_b32 s58, s101, 2
    s_add_u32 s58, s58, s96
    s_mov_b64 exec, 1
    s_cmp_lg_u32 s3, 0
    s_cbranch_scc1 Lps_87
    buffer_store_dword v15, v13, s[28:31], s58 offen offset:128
    s_branch Lpf_88
Lps_87:
    buffer_wbl2 sc1
    s_waitcnt vmcnt(0)
    buffer_store_dword v15, v13, s[28:31], s58 offen offset:128 sc1
Lpf_88:
    s_mov_b64 exec, -1
Lj_84:
    s_barrier
    v_lshrrev_b32 v32, 3, v1
    v_and_b32 v33, 7, v1
    v_bfe_u32 v34, v32, 1, 1
    v_lshlrev_b32 v34, 2, v34
    v_xor_b32 v33, v33, v34
    v_lshlrev_b32 v3, 10, v32
    v_lshl_add_u32 v3, v33, 4, v3
    s_mov_b32 s32, s16
    s_mov_b32 s33, s17
    s_mov_b32 s34, 1835008
    s_mov_b32 s35, 0x20000
    s_lshr_b32 s47, s26, 1
    s_mul_i32 s48, s47, 458752
    s_and_b32 s46, s26, 1
    s_lshl_b32 s51, s46, 13
    s_add_u32 s48, s48, s51
    s_lshl_b32 s51, s45, 7
    s_add_u32 s48, s48, s51
    v_lshrrev_b32 v32, 5, v1
    v_bfe_u32 v33, v1, 2, 2
    v_lshl_add_u32 v32, v32, 2, v33
    v_lshlrev_b32 v26, 7, v32
    v_lshrrev_b32 v33, 1, v33
    v_lshl_add_u32 v26, v33, 6, v26
    v_bfe_u32 v33, v1, 4, 1
    v_lshl_add_u32 v26, v33, 5, v26
    v_and_b32 v33, 3, v1
    v_lshl_add_u32 v26, v33, 3, v26
    s_lshl_b32 s50, s47, 11
    s_add_u32 s50, s50, 65536
    v_add_u32 v26, s50, v26
    v_xor_b32 v27, 64, v26
    s_lshl_b32 s51, s44, 1
    s_add_u32 s51, s51, s46
    s_lshl_b32 s51, s51, 2
    s_add_u32 s51, s51, s47
    s_mul_i32 s51, s51, 28672
    s_add_u32 s51, s51, 9437184
    s_add_u32 s10, s25, 0
    s_cmp_ge_u32 s10, 7
    s_cselect_b32 s87, 7, 0
    s_sub_u32 s10, s10, s87
    s_lshl_b32 s10, s10, 3
    s_add_u32 s10, s10, s26
    s_and_b32 s11, s101, 3
    s_mul_i32 s11, s11, 56
    s_add_u32 s10, s10, s11
    s_lshl_b32 s10, s10, 13
    s_add_u32 s10, s16, s10
    s_addc_u32 s11, s17, 0
    global_load_dword v15, v14, s[10:11]
    s_add_u32 s10, s25, 1
    s_cmp_ge_u32 s10, 7
    s_cselect_b32 s87, 7, 0
    s_sub_u32 s10, s10, s87
    s_lshl_b32 s10, s10, 3
    s_add_u32 s10, s10, s26
    s_and_b32 s11, s101, 3
    s_mul_i32 s11, s11, 56
    s_add_u32 s10, s10, s11
    s_lshl_b32 s10, s10, 13
    s_add_u32 s10, s16, s10
    s_addc_u32 s11, s17, 0
    global_load_dword v15, v14, s[10:11]
    s_add_u32 s10, s25, 2
    s_cmp_ge_u32 s10, 7
    s_cselect_b32 s87, 7, 0
    s_sub_u32 s10, s10, s87
    s_lshl_b32 s10, s10, 3
    s_add_u32 s10, s10, s26
    s_and_b32 s11, s101, 3
    s_mul_i32 s11, s11, 56
    s_add_u32 s10, s10, s11
    s_lshl_b32 s10, s10, 13
    s_add_u32 s10, s16, s10
    s_addc_u32 s11, s17, 0
    global_load_dword v15, v14, s[10:11]
    s_add_u32 s10, s25, 3
    s_cmp_ge_u32 s10, 7
    s_cselect_b32 s87, 7, 0
    s_sub_u32 s10, s10, s87
    s_lshl_b32 s10, s10, 3
    s_add_u32 s10, s10, s26
    s_and_b32 s11, s101, 3
    s_mul_i32 s11, s11, 56
    s_add_u32 s10, s10, s11
    s_lshl_b32 s10, s10, 13
    s_add_u32 s10, s16, s10
    s_addc_u32 s11, s17, 0
    global_load_dword v15, v14, s[10:11]
    s_add_u32 s10, s25, 4
    s_cmp_ge_u32 s10, 7
    s_cselect_b32 s87, 7, 0
    s_sub_u32 s10, s10, s87
    s_lshl_b32 s10, s10, 3
    s_add_u32 s10, s10, s26
    s_and_b32 s11, s101, 3
    s_mul_i32 s11, s11, 56
    s_add_u32 s10, s10, s11
    s_lshl_b32 s10, s10, 13
    s_add_u32 s10, s16, s10
    s_addc_u32 s11, s17, 0
    global_load_dword v15, v14, s[10:11]
    s_add_u32 s10, s25, 5
    s_cmp_ge_u32 s10, 7
    s_cselect_b32 s87, 7, 0
    s_sub_u32 s10, s10, s87
    s_lshl_b32 s10, s10, 3
    s_add_u32 s10, s10, s26
    s_and_b32 s11, s101, 3
    s_mul_i32 s11, s11, 56
    s_add_u32 s10, s10, s11
    s_lshl_b32 s10, s10, 13
    s_add_u32 s10, s16, s10
    s_addc_u32 s11, s17, 0
    global_load_dword v15, v14, s[10:11]
    s_add_u32 s10, s25, 6
    s_cmp_ge_u32 s10, 7
    s_cselect_b32 s87, 7, 0
    s_sub_u32 s10, s10, s87
    s_lshl_b32 s10, s10, 3
    s_add_u32 s10, s10, s26
    s_and_b32 s11, s101, 3
    s_mul_i32 s11, s11, 56
    s_add_u32 s10, s10, s11
    s_lshl_b32 s10, s10, 13
    s_add_u32 s10, s16, s10
    s_addc_u32 s11, s17, 0
    global_load_dword v15, v14, s[10:11]
    s_waitcnt vmcnt(0) lgkmcnt(0)
    s_add_u32 s49, s25, 0
    s_cmp_ge_u32 s49, 7
    s_cselect_b32 s87, 7, 0
    s_sub_u32 s49, s49, s87
    s_lshl_b32 s49, s49, 16
    s_add_u32 s49, s49, s48
    s_add_u32 m0, s86, 49152
    s_add_u32 s50, s49, 0
    buffer_load_dwordx4 v3, s[32:35], s50 offen lds
    s_add_u32 m0, s86, 57344
    s_add_u32 s50, s49, 16384
    buffer_load_dwordx4 v3, s[32:35], s50 offen lds
    s_add_u32 m0, s86, 131072
    s_add_u32 s50, s49, 32768
    buffer_load_dwordx4 v3, s[32:35], s50 offen lds
    s_add_u32 m0, s86, 139264
    s_add_u32 s50, s49, 49152
    buffer_load_dwordx4 v3, s[32:35], s50 offen lds
    s_add_u32 s49, s25, 1
    s_cmp_ge_u32 s49, 7
    s_cselect_b32 s87, 7, 0
    s_sub_u32 s49, s49, s87
    s_lshl_b32 s49, s49, 16
    s_add_u32 s49, s49, s48
    s_add_u32 m0, s86, 147456
    s_add_u32 s50, s49, 0
    buffer_load_dwordx4 v3, s[32:35], s50 offen lds
    s_add_u32 m0, s86, 65536
    s_add_u32 s50, s49, 16384
    buffer_load_dwordx4 v3, s[32:35], s50 offen lds
    s_add_u32 m0, s86, 73728
    s_add_u32 s50, s49, 32768
    buffer_load_dwordx4 v3, s[32:35], s50 offen lds
    s_add_u32 m0, s86, 81920
    s_add_u32 s50, s49, 49152
    buffer_load_dwordx4 v3, s[32:35], s50 offen lds
    s_add_u32 s49, s25, 2
    s_cmp_ge_u32 s49, 7
    s_cselect_b32 s87, 7, 0
    s_sub_u32 s49, s49, s87
    s_lshl_b32 s49, s49, 16
    s_add_u32 s49, s49, s48
    s_add_u32 m0, s86, 90112
    s_add_u32 s50, s49, 0
    buffer_load_dwordx4 v3, s[32:35], s50 offen lds
    s_add_u32 m0, s86, 98304
    s_add_u32 s50, s49, 16384
    buffer_load_dwordx4 v3, s[32:35], s50 offen lds
    s_add_u32 m0, s86, 106496
    s_add_u32 s50, s49, 32768
    buffer_load_dwordx4 v3, s[32:35], s50 offen lds
    s_add_u32 m0, s86, 114688
    s_add_u32 s50, s49, 49152
    buffer_load_dwordx4 v3, s[32:35], s50 offen lds
    s_add_u32 s49, s25, 3
    s_cmp_ge_u32 s49, 7
    s_cselect_b32 s87, 7, 0
    s_sub_u32 s49, s49, s87
    s_lshl_b32 s49, s49, 16
    s_add_u32 s49, s49, s48
    s_add_u32 m0, s86, 122880
    s_add_u32 s50, s49, 0
    buffer_load_dwordx4 v3, s[32:35], s50 offen lds
    s_add_u32 m0, s86, 0
    s_add_u32 s50, s49, 16384
    buffer_load_dwordx4 v3, s[32:35], s50 offen lds
    s_add_u32 m0, s86, 8192
    s_add_u32 s50, s49, 32768
    buffer_load_dwordx4 v3, s[32:35], s50 offen lds
    s_add_u32 m0, s86, 16384
    s_add_u32 s50, s49, 49152
    buffer_load_dwordx4 v3, s[32:35], s50 offen lds
    s_add_u32 s49, s25, 4
    s_cmp_ge_u32 s49, 7
    s_cselect_b32 s87, 7, 0
    s_sub_u32 s49, s49, s87
    s_lshl_b32 s49, s49, 16
    s_add_u32 s49, s49, s48
    s_add_u32 m0, s86, 24576
    s_add_u32 s50, s49, 0
    buffer_load_dwordx4 v3, s[32:35], s50 offen lds
    s_waitcnt vmcnt(0)
    s_barrier
    ds_read_b64_tr_b16 v[128:129], v26 offset:0
    ds_read_b64_tr_b16 v[130:131], v26 offset:1024
    ds_read_b64_tr_b16 v[132:133], v27 offset:0
    ds_read_b64_tr_b16 v[134:135], v27 offset:1024
    ds_read_b64_tr_b16 v[136:137], v26 offset:8192
    ds_read_b64_tr_b16 v[138:139], v26 offset:9216
    ds_read_b64_tr_b16 v[140:141], v27 offset:8192
    ds_read_b64_tr_b16 v[142:143], v27 offset:9216
    ds_read_b64_tr_b16 v[144:145], v26 offset:16384
    ds_read_b64_tr_b16 v[146:147], v26 offset:17408
    ds_read_b64_tr_b16 v[148:149], v27 offset:16384
    ds_read_b64_tr_b16 v[150:151], v27 offset:17408
    ds_read_b64_tr_b16 v[152:153], v26 offset:24576
    ds_read_b64_tr_b16 v[154:155], v26 offset:25600
    ds_read_b64_tr_b16 v[156:157], v27 offset:24576
    ds_read_b64_tr_b16 v[158:159], v27 offset:25600
    ds_read_b64_tr_b16 v[160:161], v26 offset:32768
    ds_read_b64_tr_b16 v[162:163], v26 offset:33792
    ds_read_b64_tr_b16 v[164:165], v27 offset:32768
    ds_read_b64_tr_b16 v[166:167], v27 offset:33792
    ds_read_b64_tr_b16 v[168:169], v26 offset:40960
    ds_read_b64_tr_b16 v[170:171], v26 offset:41984
    ds_read_b64_tr_b16 v[172:173], v27 offset:40960
    ds_read_b64_tr_b16 v[174:175], v27 offset:41984
    ds_read_b64_tr_b16 v[176:177], v26 offset:49152
    ds_read_b64_tr_b16 v[178:179], v26 offset:50176
    ds_read_b64_tr_b16 v[180:181], v27 offset:49152
    ds_read_b64_tr_b16 v[182:183], v27 offset:50176
    ds_read_b64_tr_b16 v[184:185], v26 offset:57344
    ds_read_b64_tr_b16 v[186:187], v26 offset:58368
    ds_read_b64_tr_b16 v[188:189], v27 offset:57344
    ds_read_b64_tr_b16 v[190:191], v27 offset:58368
    s_waitcnt lgkmcnt(0)
    s_barrier
    s_add_u32 m0, s86, 65536
    s_add_u32 s50, s49, 49152
    buffer_load_dwordx4 v3, s[32:35], s50 offen lds
    s_add_u32 s49, s25, 5
    s_cmp_ge_u32 s49, 7
    s_cselect_b32 s87, 7, 0
    s_sub_u32 s49, s49, s87
    s_lshl_b32 s49, s49, 16
    s_add_u32 s49, s49, s48
    s_add_u32 m0, s86, 73728
    s_add_u32 s50, s49, 0
    buffer_load_dwordx4 v3, s[32:35], s50 offen lds
    s_add_u32 m0, s86, 81920
    s_add_u32 s50, s49, 16384
    buffer_load_dwordx4 v3, s[32:35], s50 offen lds
    s_add_u32 m0, s86, 90112
    s_add_u32 s50, s49, 32768
    buffer_load_dwordx4 v3, s[32:35], s50 offen lds
    s_add_u32 m0, s86, 98304
    s_add_u32 s50, s49, 49152
    buffer_load_dwordx4 v3, s[32:35], s50 offen lds
    s_add_u32 s49, s25, 6
    s_cmp_ge_u32 s49, 7
    s_cselect_b32 s87, 7, 0
    s_sub_u32 s49, s49, s87
    s_lshl_b32 s49, s49, 16
    s_add_u32 s49, s49, s48
    s_add_u32 m0, s86, 106496
    s_add_u32 s50, s49, 0
    buffer_load_dwordx4 v3, s[32:35], s50 offen lds
    s_add_u32 m0, s86, 114688
    s_add_u32 s50, s49, 16384
    buffer_load_dwordx4 v3, s[32:35], s50 offen lds
    s_add_u32 m0, s86, 122880
    s_add_u32 s50, s49, 32768
    buffer_load_dwordx4 v3, s[32:35], s50 offen lds
L_gj:
    v_subrev_u32 v4, 65536, v26
    v_subrev_u32 v5, 65536, v27
    v_add_u32 v6, 65536, v26
    v_add_u32 v7, 65536, v27
    v_lshlrev_b32 v13, 2, v1
    s_waitcnt lgkmcnt(0)
    s_barrier
    s_add_u32 s49, s25, 4
    s_cmp_ge_u32 s49, 7
    s_cselect_b32 s87, 7, 0
    s_sub_u32 s49, s49, s87
    s_lshl_b32 s49, s49, 16
    s_add_u32 s49, s49, s48
    s_add_u32 m0, s86, 32768
    s_add_u32 s50, s49, 16384
    buffer_load_dwordx4 v3, s[32:35], s50 offen lds
    s_add_u32 m0, s86, 40960
    s_add_u32 s50, s49, 32768
    buffer_load_dwordx4 v3, s[32:35], s50 offen lds
    s_add_u32 s49, s25, 6
    s_cmp_ge_u32 s49, 7
    s_cselect_b32 s87, 7, 0
    s_sub_u32 s49, s49, s87
    s_lshl_b32 s49, s49, 16
    s_add_u32 s49, s49, s48
    s_add_u32 m0, s86, 155648
    s_add_u32 s50, s49, 49152
    buffer_load_dwordx4 v3, s[32:35], s50 offen lds
    s_cmp_ge_u32 s101, 28
    s_cbranch_scc1 Lo_90
    s_lshl_b32 s58, s101, 2
    s_lshl_b32 s59, s26, 7
    s_add_u32 s58, s58, s59
    s_add_u32 s58, s58, s96
    v_mov_b32 v15, s99
    s_mov_b64 exec, 1
    s_cmp_lg_u32 s3, 0
    s_waitcnt vmcnt(3)
    s_cbranch_scc1 Lps_91
    buffer_store_dword v15, v13, s[28:31], s58 offen offset:2048
    s_branch Lpf_92
Lps_91:
    buffer_store_dword v15, v13, s[28:31], s58 offen offset:2048 sc1
Lpf_92:
    s_mov_b64 exec, -1
Lo_90:
    s_and_b32 s58, s44, 3
    s_lshl1_add_u32 s58, s58, s46
    s_lshl_b32 s58, s58, 7
    s_add_u32 s58, s58, s96
    s_mul_i32 s60, s47, 7
    s_lshl_b32 s60, 0x7f, s60
    s_mov_b32 s61, 0
    s_mov_b32 s59, 0
Lp_93:
    buffer_load_dword v31, v13, s[28:31], s58 offen offset:2048 sc1
    s_add_u32 s59, s59, 1
    s_waitcnt vmcnt(0)
    v_cmp_ne_u32 vcc, s99, v31
    s_cmp_gt_u32 s59, 200000
    s_cbranch_scc1 Lpd_94
    s_and_b64 vcc, vcc, s[60:61]
    s_cbranch_scc1 Lp_93
Lpd_94:
    s_cmp_eq_u32 s3, 0
    s_cbranch_scc1 Lpe_95
    buffer_inv sc1
    s_waitcnt vmcnt(0)
Lpe_95:
    s_add_u32 s52, s25, 1
    s_cmp_ge_u32 s52, 7
    s_cselect_b32 s87, 7, 0
    s_sub_u32 s52, s52, s87
    s_lshl_b32 s52, s52, 12
    s_add_u32 s52, s52, s51
    buffer_load_dwordx4 v[192:195], v2, s[28:31], s52 offen offset:1024 sc1
    buffer_load_dwordx4 v[196:199], v2, s[28:31], s52 offen offset:2048 sc1
    buffer_load_dwordx4 v[200:203], v2, s[28:31], s52 offen offset:3072 sc1
    s_add_u32 s52, s25, 2
    s_cmp_ge_u32 s52, 7
    s_cselect_b32 s87, 7, 0
    s_sub_u32 s52, s52, s87
    s_lshl_b32 s52, s52, 12
    s_add_u32 s52, s52, s51
    buffer_load_dwordx4 v[204:207], v2, s[28:31], s52 offen offset:0 sc1
    buffer_load_dwordx4 v[208:211], v2, s[28:31], s52 offen offset:1024 sc1
    buffer_load_dwordx4 v[212:215], v2, s[28:31], s52 offen offset:2048 sc1
    buffer_load_dwordx4 v[216:219], v2, s[28:31], s52 offen offset:3072 sc1
    s_add_u32 s52, s25, 3
    s_cmp_ge_u32 s52, 7
    s_cselect_b32 s87, 7, 0
    s_sub_u32 s52, s52, s87
    s_lshl_b32 s52, s52, 12
    s_add_u32 s52, s52, s51
    buffer_load_dwordx4 v[220:223], v2, s[28:31], s52 offen offset:0 sc1
    s_waitcnt vmcnt(7)
    v_mfma_f32_32x32x16_bf16 v[64:79], v[128:131], v[192:195], 0
    buffer_load_dwordx4 v[224:227], v2, s[28:31], s52 offen offset:1024 sc1
    v_mfma_f32_32x32x16_bf16 v[80:95], v[132:135], v[192:195], 0
    s_waitcnt vmcnt(7)
    v_mfma_f32_32x32x16_bf16 v[64:79], v[136:139], v[196:199], v[64:79]
    buffer_load_dwordx4 v[228:231], v2, s[28:31], s52 offen offset:2048 sc1
    v_mfma_f32_32x32x16_bf16 v[80:95], v[140:143], v[196:199], v[80:95]
    s_waitcnt vmcnt(7)
    v_mfma_f32_32x32x16_bf16 v[64:79], v[144:147], v[200:203], v[64:79]
    buffer_load_dwordx4 v[232:235], v2, s[28:31], s52 offen offset:3072 sc1
    v_mfma_f32_32x32x16_bf16 v[80:95], v[148:151], v[200:203], v[80:95]
    s_waitcnt vmcnt(7)
    v_mfma_f32_32x32x16_bf16 v[64:79], v[152:155], v[204:207], v[64:79]
    s_add_u32 s52, s25, 4
    s_cmp_ge_u32 s52, 7
    s_cselect_b32 s87, 7, 0
    s_sub_u32 s52, s52, s87
    s_lshl_b32 s52, s52, 12
    s_add_u32 s52, s52, s51
    buffer_load_dwordx4 v[236:239], v2, s[28:31], s52 offen offset:0 sc1
    v_mfma_f32_32x32x16_bf16 v[80:95], v[156:159], v[204:207], v[80:95]
    s_waitcnt vmcnt(7)
    v_mfma_f32_32x32x16_bf16 v[64:79], v[160:163], v[208:211], v[64:79]
    s_add_u32 s52, s25, 0
    s_cmp_ge_u32 s52, 7
    s_cselect_b32 s87, 7, 0
    s_sub_u32 s52, s52, s87
    s_lshl_b32 s52, s52, 12
    s_add_u32 s52, s52, s51
    buffer_load_dwordx4 v[240:243], v2, s[28:31], s52 offen offset:0 sc1
    v_mfma_f32_32x32x16_bf16 v[80:95], v[164:167], v[208:211], v[80:95]
    s_waitcnt vmcnt(7)
    v_mfma_f32_32x32x16_bf16 v[64:79], v[168:171], v[212:215], v[64:79]
    buffer_load_dwordx4 v[244:247], v2, s[28:31], s52 offen offset:1024 sc1
    v_mfma_f32_32x32x16_bf16 v[80:95], v[172:175], v[212:215], v[80:95]
    s_barrier
    s_waitcnt vmcnt(7)
    v_mfma_f32_32x32x16_bf16 v[64:79], v[176:179], v[216:219], v[64:79]
    buffer_load_dwordx4 v[248:251], v2, s[28:31], s52 offen offset:2048 sc1
    v_mfma_f32_32x32x16_bf16 v[80:95], v[180:183], v[216:219], v[80:95]
    s_waitcnt vmcnt(7)
    v_mfma_f32_32x32x16_bf16 v[64:79], v[184:187], v[220:223], v[64:79]
    buffer_load_dwordx4 v[252:255], v2, s[28:31], s52 offen offset:3072 sc1
    ds_read_b64_tr_b16 v[32:33], v4 offset:0
    ds_read_b64_tr_b16 v[34:35], v4 offset:1024
    ds_read_b64_tr_b16 v[36:37], v5 offset:0
    ds_read_b64_tr_b16 v[38:39], v5 offset:1024
    v_mfma_f32_32x32x16_bf16 v[80:95], v[188:191], v[220:223], v[80:95]
    s_waitcnt vmcnt(7) lgkmcnt(2)
    v_mfma_f32_32x32x16_bf16 v[64:79], v[32:35], v[224:227], v[64:79]
    s_add_u32 s52, s25, 1
    s_cmp_ge_u32 s52, 7
    s_cselect_b32 s87, 7, 0
    s_sub_u32 s52, s52, s87
    s_lshl_b32 s52, s52, 12
    s_add_u32 s52, s52, s51
    buffer_load_dwordx4 v[96:99], v2, s[28:31], s52 offen offset:0 sc1
    ds_read_b64_tr_b16 v[40:41], v4 offset:8192
    ds_read_b64_tr_b16 v[42:43], v4 offset:9216
    ds_read_b64_tr_b16 v[44:45], v5 offset:8192
    ds_read_b64_tr_b16 v[46:47], v5 offset:9216
    s_waitcnt lgkmcnt(4)
    v_mfma_f32_32x32x16_bf16 v[80:95], v[36:39], v[224:227], v[80:95]
    s_waitcnt vmcnt(7) lgkmcnt(2)
    v_mfma_f32_32x32x16_bf16 v[64:79], v[40:43], v[228:231], v[64:79]
    s_add_u32 s52, s25, 4
    s_cmp_ge_u32 s52, 7
    s_cselect_b32 s87, 7, 0
    s_sub_u32 s52, s52, s87
    s_lshl_b32 s52, s52, 12
    s_add_u32 s52, s52, s51
    buffer_load_dwordx4 v[100:103], v2, s[28:31], s52 offen offset:1024 sc1
    ds_read_b64_tr_b16 v[32:33], v4 offset:16384
    ds_read_b64_tr_b16 v[34:35], v4 offset:17408
    ds_read_b64_tr_b16 v[36:37], v5 offset:16384
    ds_read_b64_tr_b16 v[38:39], v5 offset:17408
    s_waitcnt lgkmcnt(4)
    v_mfma_f32_32x32x16_bf16 v[80:95], v[44:47], v[228:231], v[80:95]
    s_waitcnt vmcnt(7) lgkmcnt(2)
    v_mfma_f32_32x32x16_bf16 v[64:79], v[32:35], v[232:235], v[64:79]
    buffer_load_dwordx4 v[104:107], v2, s[28:31], s52 offen offset:2048 sc1
    ds_read_b64_tr_b16 v[40:41], v4 offset:24576
    ds_read_b64_tr_b16 v[42:43], v4 offset:25600
    ds_read_b64_tr_b16 v[44:45], v5 offset:24576
    ds_read_b64_tr_b16 v[46:47], v5 offset:25600
    s_waitcnt lgkmcnt(4)
    v_mfma_f32_32x32x16_bf16 v[80:95], v[36:39], v[232:235], v[80:95]
    s_waitcnt vmcnt(7) lgkmcnt(2)
    v_mfma_f32_32x32x16_bf16 v[64:79], v[40:43], v[236:239], v[64:79]
    buffer_load_dwordx4 v[108:111], v2, s[28:31], s52 offen offset:3072 sc1
    ds_read_b64_tr_b16 v[32:33], v4 offset:49152
    ds_read_b64_tr_b16 v[34:35], v4 offset:50176
    ds_read_b64_tr_b16 v[36:37], v5 offset:49152
    ds_read_b64_tr_b16 v[38:39], v5 offset:50176
    s_waitcnt lgkmcnt(4)
    v_mfma_f32_32x32x16_bf16 v[80:95], v[44:47], v[236:239], v[80:95]
    s_waitcnt vmcnt(7) lgkmcnt(2)
    v_mfma_f32_32x32x16_bf16 v[64:79], v[32:35], v[240:243], v[64:79]
    s_add_u32 s52, s25, 5
    s_cmp_ge_u32 s52, 7
    s_cselect_b32 s87, 7, 0
    s_sub_u32 s52, s52, s87
    s_lshl_b32 s52, s52, 12
    s_add_u32 s52, s52, s51
    buffer_load_dwordx4 v[112:115], v2, s[28:31], s52 offen offset:0 sc1
    ds_read_b64_tr_b16 v[40:41], v4 offset:57344
    ds_read_b64_tr_b16 v[42:43], v4 offset:58368
    ds_read_b64_tr_b16 v[44:45], v5 offset:57344
    ds_read_b64_tr_b16 v[46:47], v5 offset:58368
    s_waitcnt lgkmcnt(4)
    v_mfma_f32_32x32x16_bf16 v[80:95], v[36:39], v[240:243], v[80:95]
    s_waitcnt vmcnt(7) lgkmcnt(2)
    v_mfma_f32_32x32x16_bf16 v[64:79], v[40:43], v[244:247], v[64:79]
    buffer_load_dwordx4 v[116:119], v2, s[28:31], s52 offen offset:1024 sc1
    ds_read_b64_tr_b16 v[32:33], v6 offset:0
    ds_read_b64_tr_b16 v[34:35], v6 offset:1024
    ds_read_b64_tr_b16 v[36:37], v7 offset:0
    ds_read_b64_tr_b16 v[38:39], v7 offset:1024
    s_waitcnt lgkmcnt(4)
    v_mfma_f32_32x32x16_bf16 v[80:95], v[44:47], v[244:247], v[80:95]
    s_waitcnt vmcnt(7) lgkmcnt(2)
    v_mfma_f32_32x32x16_bf16 v[64:79], v[32:35], v[248:251], v[64:79]
    buffer_load_dwordx4 v[120:123], v2, s[28:31], s52 offen offset:2048 sc1
    ds_read_b64_tr_b16 v[40:41], v6 offset:8192
    ds_read_b64_tr_b16 v[42:43], v6 offset:9216
    ds_read_b64_tr_b16 v[44:45], v7 offset:8192
    ds_read_b64_tr_b16 v[46:47], v7 offset:9216
    s_waitcnt lgkmcnt(4)
    v_mfma_f32_32x32x16_bf16 v[80:95], v[36:39], v[248:251], v[80:95]
    s_waitcnt vmcnt(7) lgkmcnt(2)
    v_mfma_f32_32x32x16_bf16 v[64:79], v[40:43], v[252:255], v[64:79]
    buffer_load_dwordx4 v[124:127], v2, s[28:31], s52 offen offset:3072 sc1
    ds_read_b64_tr_b16 v[32:33], v6 offset:16384
    ds_read_b64_tr_b16 v[34:35], v6 offset:17408
    ds_read_b64_tr_b16 v[36:37], v7 offset:16384
    ds_read_b64_tr_b16 v[38:39], v7 offset:17408
    s_waitcnt lgkmcnt(4)
    v_mfma_f32_32x32x16_bf16 v[80:95], v[44:47], v[252:255], v[80:95]
    s_waitcnt vmcnt(7) lgkmcnt(2)
    v_mfma_f32_32x32x16_bf16 v[64:79], v[32:35], v[96:99], v[64:79]
    s_add_u32 s52, s25, 6
    s_cmp_ge_u32 s52, 7
    s_cselect_b32 s87, 7, 0
    s_sub_u32 s52, s52, s87
    s_lshl_b32 s52, s52, 12
    s_add_u32 s52, s52, s51
    buffer_load_dwordx4 v[48:51], v2, s[28:31], s52 offen offset:0 sc1
    ds_read_b64_tr_b16 v[40:41], v4 offset:32768
    ds_read_b64_tr_b16 v[42:43], v4 offset:33792
    ds_read_b64_tr_b16 v[44:45], v5 offset:32768
    ds_read_b64_tr_b16 v[46:47], v5 offset:33792
    s_waitcnt lgkmcnt(4)
    v_mfma_f32_32x32x16_bf16 v[80:95], v[36:39], v[96:99], v[80:95]
    s_waitcnt vmcnt(7) lgkmcnt(2)
    v_mfma_f32_32x32x16_bf16 v[64:79], v[40:43], v[100:103], v[64:79]
    buffer_load_dwordx4 v[52:55], v2, s[28:31], s52 offen offset:1024 sc1
    ds_read_b64_tr_b16 v[32:33], v4 offset:40960
    ds_read_b64_tr_b16 v[34:35], v4 offset:41984
    ds_read_b64_tr_b16 v[36:37], v5 offset:40960
    ds_read_b64_tr_b16 v[38:39], v5 offset:41984
    s_waitcnt lgkmcnt(4)
    v_mfma_f32_32x32x16_bf16 v[80:95], v[44:47], v[100:103], v[80:95]
    s_waitcnt vmcnt(7) lgkmcnt(2)
    v_mfma_f32_32x32x16_bf16 v[64:79], v[32:35], v[104:107], v[64:79]
    buffer_load_dwordx4 v[56:59], v2, s[28:31], s52 offen offset:2048 sc1
    ds_read_b64_tr_b16 v[40:41], v26 offset:0
    ds_read_b64_tr_b16 v[42:43], v26 offset:1024
    ds_read_b64_tr_b16 v[44:45], v27 offset:0
    ds_read_b64_tr_b16 v[46:47], v27 offset:1024
    s_waitcnt lgkmcnt(4)
    v_mfma_f32_32x32x16_bf16 v[80:95], v[36:39], v[104:107], v[80:95]
    s_waitcnt vmcnt(7) lgkmcnt(2)
    v_mfma_f32_32x32x16_bf16 v[64:79], v[40:43], v[108:111], v[64:79]
    buffer_load_dwordx4 v[60:63], v2, s[28:31], s52 offen offset:3072 sc1
    ds_read_b64_tr_b16 v[32:33], v26 offset:8192
    ds_read_b64_tr_b16 v[34:35], v26 offset:9216
    ds_read_b64_tr_b16 v[36:37], v27 offset:8192
    ds_read_b64_tr_b16 v[38:39], v27 offset:9216
    s_waitcnt lgkmcnt(4)
    v_mfma_f32_32x32x16_bf16 v[80:95], v[44:47], v[108:111], v[80:95]
    s_barrier
    s_waitcnt vmcnt(7) lgkmcnt(2)
    v_mfma_f32_32x32x16_bf16 v[64:79], v[32:35], v[112:115], v[64:79]
    ds_read_b64_tr_b16 v[40:41], v26 offset:16384
    ds_read_b64_tr_b16 v[42:43], v26 offset:17408
    ds_read_b64_tr_b16 v[44:45], v27 offset:16384
    ds_read_b64_tr_b16 v[46:47], v27 offset:17408
    s_waitcnt lgkmcnt(4)
    v_mfma_f32_32x32x16_bf16 v[80:95], v[36:39], v[112:115], v[80:95]
    v_lshrrev_b32 v14, 5, v1
    v_lshlrev_b32 v14, 3, v14
    s_sub_u32 s53, s45, s100
    s_and_b32 s53, s53, 7
    s_lshl_b32 s53, s53, 7
    s_lshl_b32 s54, s47, 5
    s_add_u32 s53, s53, s54
    s_add_u32 s53, s53, 6144
    s_add_u32 s53, s53, s97
    buffer_load_dwordx2 v[8:9], v14, s[28:31], s53 offen offset:0 sc1
    buffer_load_dwordx2 v[20:21], v14, s[28:31], s53 offen offset:16 sc1
    s_and_b32 s53, s44, 3
    s_lshl_b32 s53, s53, 1
    s_add_u32 s53, s53, s46
    s_lshl_b32 s53, s53, 7
    s_add_u32 s53, s53, s96
    v_and_b32 v14, 0x7f, v13
    buffer_load_dword v24, v14, s[28:31], s53 offen offset:1024 sc1
    s_waitcnt vmcnt(9) lgkmcnt(2)
    v_mfma_f32_32x32x16_bf16 v[64:79], v[40:43], v[116:119], v[64:79]
    ds_read_b64_tr_b16 v[32:33], v26 offset:24576
    ds_read_b64_tr_b16 v[34:35], v26 offset:25600
    ds_read_b64_tr_b16 v[36:37], v27 offset:24576
    ds_read_b64_tr_b16 v[38:39], v27 offset:25600
    s_waitcnt lgkmcnt(4)
    v_mfma_f32_32x32x16_bf16 v[80:95], v[44:47], v[116:119], v[80:95]
    s_waitcnt vmcnt(8) lgkmcnt(2)
    v_mfma_f32_32x32x16_bf16 v[64:79], v[32:35], v[120:123], v[64:79]
    ds_read_b64_tr_b16 v[40:41], v26 offset:32768
    ds_read_b64_tr_b16 v[42:43], v26 offset:33792
    ds_read_b64_tr_b16 v[44:45], v27 offset:32768
    ds_read_b64_tr_b16 v[46:47], v27 offset:33792
    s_waitcnt lgkmcnt(4)
    v_mfma_f32_32x32x16_bf16 v[80:95], v[36:39], v[120:123], v[80:95]
    s_waitcnt vmcnt(7) lgkmcnt(2)
    v_mfma_f32_32x32x16_bf16 v[64:79], v[40:43], v[124:127], v[64:79]
    ds_read_b64_tr_b16 v[32:33], v26 offset:40960
    ds_read_b64_tr_b16 v[34:35], v26 offset:41984
    ds_read_b64_tr_b16 v[36:37], v27 offset:40960
    ds_read_b64_tr_b16 v[38:39], v27 offset:41984
    s_waitcnt lgkmcnt(4)
    v_mfma_f32_32x32x16_bf16 v[80:95], v[44:47], v[124:127], v[80:95]
    s_waitcnt vmcnt(6) lgkmcnt(2)
    v_mfma_f32_32x32x16_bf16 v[64:79], v[32:35], v[48:51], v[64:79]
    ds_read_b64_tr_b16 v[40:41], v26 offset:49152
    ds_read_b64_tr_b16 v[42:43], v26 offset:50176
    ds_read_b64_tr_b16 v[44:45], v27 offset:49152
    ds_read_b64_tr_b16 v[46:47], v27 offset:50176
    s_waitcnt lgkmcnt(4)
    v_mfma_f32_32x32x16_bf16 v[80:95], v[36:39], v[48:51], v[80:95]
    s_waitcnt vmcnt(5) lgkmcnt(2)
    v_mfma_f32_32x32x16_bf16 v[64:79], v[40:43], v[52:55], v[64:79]
    ds_read_b64_tr_b16 v[32:33], v26 offset:57344
    ds_read_b64_tr_b16 v[34:35], v26 offset:58368
    ds_read_b64_tr_b16 v[36:37], v27 offset:57344
    ds_read_b64_tr_b16 v[38:39], v27 offset:58368
    s_waitcnt lgkmcnt(4)
    v_mfma_f32_32x32x16_bf16 v[80:95], v[44:47], v[52:55], v[80:95]
    s_waitcnt vmcnt(4) lgkmcnt(2)
    v_mfma_f32_32x32x16_bf16 v[64:79], v[32:35], v[56:59], v[64:79]
    ds_read_b64_tr_b16 v[40:41], v6 offset:24576
    ds_read_b64_tr_b16 v[42:43], v6 offset:25600
    ds_read_b64_tr_b16 v[44:45], v7 offset:24576
    ds_read_b64_tr_b16 v[46:47], v7 offset:25600
    s_waitcnt lgkmcnt(4)
    v_mfma_f32_32x32x16_bf16 v[80:95], v[36:39], v[56:59], v[80:95]
    s_waitcnt vmcnt(3) lgkmcnt(2)
    v_mfma_f32_32x32x16_bf16 v[64:79], v[40:43], v[60:63], v[64:79]
    s_waitcnt lgkmcnt(0)
    v_mfma_f32_32x32x16_bf16 v[80:95], v[44:47], v[60:63], v[80:95]
    v_and_b32 v28, 15, v1
    v_lshlrev_b32 v28, 11, v28
    v_bfe_u32 v29, v1, 4, 1
    v_lshl_add_u32 v28, v29, 10, v28
    v_lshrrev_b32 v29, 5, v1
    v_lshl_add_u32 v28, v29, 4, v28
    s_lshl_b32 s52, s44, 1
    s_add_u32 s52, s52, s46
    s_lshl_b32 s52, s52, 15
    s_lshl_b32 s53, s45, 7
    s_add_u32 s52, s52, s53
    s_lshl_b32 s53, s47, 5
    s_add_u32 s52, s52, s53
    s_mov_b32 s36, s20
    s_mov_b32 s37, s21
    s_mov_b32 s38, 2097152
    s_mov_b32 s39, 0x20000
    s_mul_i32 s53, s46, 24576
    s_cmp_lg_u32 s47, 0
    s_cbranch_scc1 L_de1
    s_mov_b32 m0, s53
    s_nop 0
    ds_write_addtid_b32 v72 offset:6144
    ds_write_addtid_b32 v73 offset:6400
    ds_write_addtid_b32 v74 offset:6656
    ds_write_addtid_b32 v75 offset:6912
    ds_write_addtid_b32 v76 offset:7168
    ds_write_addtid_b32 v77 offset:7424
    ds_write_addtid_b32 v78 offset:7680
    ds_write_addtid_b32 v79 offset:7936
    ds_write_addtid_b32 v80 offset:12288
    ds_write_addtid_b32 v81 offset:12544
    ds_write_addtid_b32 v82 offset:12800
    ds_write_addtid_b32 v83 offset:13056
    ds_write_addtid_b32 v84 offset:13312
    ds_write_addtid_b32 v85 offset:13568
    ds_write_addtid_b32 v86 offset:13824
    ds_write_addtid_b32 v87 offset:14080
    ds_write_addtid_b32 v88 offset:18432
    ds_write_addtid_b32 v89 offset:18688
    ds_write_addtid_b32 v90 offset:18944
    ds_write_addtid_b32 v91 offset:19200
    ds_write_addtid_b32 v92 offset:19456
    ds_write_addtid_b32 v93 offset:19712
    ds_write_addtid_b32 v94 offset:19968
    ds_write_addtid_b32 v95 offset:20224
    v_mov_b32 v32, v64
    v_mov_b32 v33, v65
    v_mov_b32 v34, v66
    v_mov_b32 v35, v67
    v_mov_b32 v36, v68
    v_mov_b32 v37, v69
    v_mov_b32 v38, v70
    v_mov_b32 v39, v71
    s_branch L_dej
L_de1:
    s_cmp_lg_u32 s47, 1
    s_cbranch_scc1 L_de2
    s_mov_b32 m0, s53
    s_nop 0
    ds_write_addtid_b32 v64 offset:0
    ds_write_addtid_b32 v65 offset:256
    ds_write_addtid_b32 v66 offset:512
    ds_write_addtid_b32 v67 offset:768
    ds_write_addtid_b32 v68 offset:1024
    ds_write_addtid_b32 v69 offset:1280
    ds_write_addtid_b32 v70 offset:1536
    ds_write_addtid_b32 v71 offset:1792
    ds_write_addtid_b32 v80 offset:14336
    ds_write_addtid_b32 v81 offset:14592
    ds_write_addtid_b32 v82 offset:14848
    ds_write_addtid_b32 v83 offset:15104
    ds_write_addtid_b32 v84 offset:15360
    ds_write_addtid_b32 v85 offset:15616
    ds_write_addtid_b32 v86 offset:15872
    ds_write_addtid_b32 v87 offset:16128
    ds_write_addtid_b32 v88 offset:20480
    ds_write_addtid_b32 v89 offset:20736
    ds_write_addtid_b32 v90 offset:20992
    ds_write_addtid_b32 v91 offset:21248
    ds_write_addtid_b32 v92 offset:21504
    ds_write_addtid_b32 v93 offset:21760
    ds_write_addtid_b32 v94 offset:22016
    ds_write_addtid_b32 v95 offset:22272
    v_mov_b32 v32, v72
    v_mov_b32 v33, v73
    v_mov_b32 v34, v74
    v_mov_b32 v35, v75
    v_mov_b32 v36, v76
    v_mov_b32 v37, v77
    v_mov_b32 v38, v78
    v_mov_b32 v39, v79
    s_branch L_dej
L_de2:
    s_cmp_lg_u32 s47, 2
    s_cbranch_scc1 L_de3
    s_mov_b32 m0, s53
    s_nop 0
    ds_write_addtid_b32 v64 offset:2048
    ds_write_addtid_b32 v65 offset:2304
    ds_write_addtid_b32 v66 offset:2560
    ds_write_addtid_b32 v67 offset:2816
    ds_write_addtid_b32 v68 offset:3072
    ds_write_addtid_b32 v69 offset:3328
    ds_write_addtid_b32 v70 offset:3584
    ds_write_addtid_b32 v71 offset:3840
    ds_write_addtid_b32 v72 offset:8192
    ds_write_addtid_b32 v73 offset:8448
    ds_write_addtid_b32 v74 offset:8704
    ds_write_addtid_b32 v75 offset:8960
    ds_write_addtid_b32 v76 offset:9216
    ds_write_addtid_b32 v77 offset:9472
    ds_write_addtid_b32 v78 offset:9728
    ds_write_addtid_b32 v79 offset:9984
    ds_write_addtid_b32 v88 offset:22528
    ds_write_addtid_b32 v89 offset:22784
    ds_write_addtid_b32 v90 offset:23040
    ds_write_addtid_b32 v91 offset:23296
    ds_write_addtid_b32 v92 offset:23552
    ds_write_addtid_b32 v93 offset:23808
    ds_write_addtid_b32 v94 offset:24064
    ds_write_addtid_b32 v95 offset:24320
    v_mov_b32 v32, v80
    v_mov_b32 v33, v81
    v_mov_b32 v34, v82
    v_mov_b32 v35, v83
    v_mov_b32 v36, v84
    v_mov_b32 v37, v85
    v_mov_b32 v38, v86
    v_mov_b32 v39, v87
    s_branch L_dej
L_de3:
    s_mov_b32 m0, s53
    s_nop 0
    ds_write_addtid_b32 v64 offset:4096
    ds_write_addtid_b32 v65 offset:4352
    ds_write_addtid_b32 v66 offset:4608
    ds_write_addtid_b32 v67 offset:4864
    ds_write_addtid_b32 v68 offset:5120
    ds_write_addtid_b32 v69 offset:5376
    ds_write_addtid_b32 v70 offset:5632
    ds_write_addtid_b32 v71 offset:5888
    ds_write_addtid_b32 v72 offset:10240
    ds_write_addtid_b32 v73 offset:10496
    ds_write_addtid_b32 v74 offset:10752
    ds_write_addtid_b32 v75 offset:11008
    ds_write_addtid_b32 v76 offset:11264
    ds_write_addtid_b32 v77 offset:11520
    ds_write_addtid_b32 v78 offset:11776
    ds_write_addtid_b32 v79 offset:12032
    ds_write_addtid_b32 v80 offset:16384
    ds_write_addtid_b32 v81 offset:16640
    ds_write_addtid_b32 v82 offset:16896
    ds_write_addtid_b32 v83 offset:17152
    ds_write_addtid_b32 v84 offset:17408
    ds_write_addtid_b32 v85 offset:17664
    ds_write_addtid_b32 v86 offset:17920
    ds_write_addtid_b32 v87 offset:18176
    v_mov_b32 v32, v88
    v_mov_b32 v33, v89
    v_mov_b32 v34, v90
    v_mov_b32 v35, v91
    v_mov_b32 v36, v92
    v_mov_b32 v37, v93
    v_mov_b32 v38, v94
    v_mov_b32 v39, v95
L_dej:
    s_mul_i32 s54, s47, 6144
    s_add_u32 s53, s53, s54
    v_add_u32 v29, s53, v13
    s_waitcnt vmcnt(0)
    v_lshlrev_b32 v40, 16, v16
    v_and_b32 v41, 0xffff0000, v16
    v_and_b32 v11, 0xffff0000, v9
    v_lshlrev_b32 v10, 16, v9
    v_lshlrev_b32 v42, 16, v17
    v_and_b32 v43, 0xffff0000, v17
    v_and_b32 v9, 0xffff0000, v8
    v_lshlrev_b32 v8, 16, v8
    v_lshlrev_b32 v44, 16, v18
    v_and_b32 v45, 0xffff0000, v18
    v_and_b32 v23, 0xffff0000, v21
    v_lshlrev_b32 v22, 16, v21
    v_lshlrev_b32 v46, 16, v19
    v_and_b32 v47, 0xffff0000, v19
    v_and_b32 v21, 0xffff0000, v20
    v_lshlrev_b32 v20, 16, v20
    v_mul_f32 v8, v8, v24
    v_mul_f32 v9, v9, v24
    v_mul_f32 v10, v10, v24
    v_mul_f32 v11, v11, v24
    v_mul_f32 v20, v20, v24
    v_mul_f32 v21, v21, v24
    v_mul_f32 v22, v22, v24
    v_mul_f32 v23, v23, v24
    s_waitcnt lgkmcnt(0)
    s_barrier
    ds_read2st64_b32 v[64:65], v29 offset0:0 offset1:1
    ds_read2st64_b32 v[66:67], v29 offset0:2 offset1:3
    ds_read2st64_b32 v[68:69], v29 offset0:4 offset1:5
    ds_read2st64_b32 v[70:71], v29 offset0:6 offset1:7
    ds_read2st64_b32 v[72:73], v29 offset0:8 offset1:9
    ds_read2st64_b32 v[74:75], v29 offset0:10 offset1:11
    ds_read2st64_b32 v[76:77], v29 offset0:12 offset1:13
    ds_read2st64_b32 v[78:79], v29 offset0:14 offset1:15
    ds_read2st64_b32 v[80:81], v29 offset0:16 offset1:17
    ds_read2st64_b32 v[82:83], v29 offset0:18 offset1:19
    ds_read2st64_b32 v[84:85], v29 offset0:20 offset1:21
    ds_read2st64_b32 v[86:87], v29 offset0:22 offset1:23
    s_waitcnt lgkmcnt(8)
    v_add_f32 v32, v32, v64
    v_add_f32 v33, v33, v65
    v_add_f32 v34, v34, v66
    v_add_f32 v35, v35, v67
    v_add_f32 v36, v36, v68
    v_add_f32 v37, v37, v69
    v_add_f32 v38, v38, v70
    v_add_f32 v39, v39, v71
    s_waitcnt lgkmcnt(4)
    v_add_f32 v32, v32, v72
    v_add_f32 v33, v33, v73
    v_add_f32 v34, v34, v74
    v_add_f32 v35, v35, v75
    v_add_f32 v36, v36, v76
    v_add_f32 v37, v37, v77
    v_add_f32 v38, v38, v78
    v_add_f32 v39, v39, v79
    s_waitcnt lgkmcnt(0)
    v_add_f32 v32, v32, v80
    v_add_f32 v33, v33, v81
    v_add_f32 v34, v34, v82
    v_add_f32 v35, v35, v83
    v_add_f32 v36, v36, v84
    v_add_f32 v37, v37, v85
    v_add_f32 v38, v38, v86
    v_add_f32 v39, v39, v87
    v_permlane32_swap_b32 v32, v36
    v_permlane32_swap_b32 v33, v37
    v_permlane32_swap_b32 v34, v38
    v_permlane32_swap_b32 v35, v39
    v_fma_f32 v32, v32, v8, v40
    v_fma_f32 v33, v33, v9, v41
    v_fma_f32 v34, v34, v10, v42
    v_fma_f32 v35, v35, v11, v43
    v_fma_f32 v36, v36, v20, v44
    v_fma_f32 v37, v37, v21, v45
    v_fma_f32 v38, v38, v22, v46
    v_fma_f32 v39, v39, v23, v47
    v_cvt_pk_bf16_f32 v8, v32, v33
    v_cvt_pk_bf16_f32 v9, v34, v35
    v_cvt_pk_bf16_f32 v10, v36, v37
    v_cvt_pk_bf16_f32 v11, v38, v39
    buffer_store_dwordx4 v[8:11], v28, s[36:39], s52 offen
L_end:
    s_endpgm
.section .rodata,"a"

.p2align 6
.amdhsa_kernel adaLN_cond__sliding_local_dilated__glu_gated_reglu__prompt_kernel
  .amdhsa_next_free_vgpr 256
  .amdhsa_next_free_sgpr 102
  .amdhsa_accum_offset 256
  .amdhsa_group_segment_fixed_size 0
  .amdhsa_kernarg_size 96
  .amdhsa_user_sgpr_count 2
  .amdhsa_user_sgpr_kernarg_segment_ptr 1
  .amdhsa_system_sgpr_workgroup_id_x 1
.end_amdhsa_kernel
```
